```python
import torch

def _softmax(x, axis=-1):
    return torch.softmax(x, dim=axis)
def _gelu(x):
    return torch.nn.functional.gelu(x, approximate="tanh")
def _silu(x):
    return torch.nn.functional.silu(x)
def _sigmoid(x):
    return torch.sigmoid(x)
def _layernorm(x, axis=-1, eps=1e-5):
    m = x.mean(dim=axis, keepdim=True)
    v = x.var(dim=axis, keepdim=True, unbiased=False)
    return (x - m) / torch.sqrt(v + eps)
def _scatter_add(tgt, idx, src, axis=0):
    return tgt.clone().index_add_(axis, idx, src)
def _segment_sum(src, seg, n):
    out = torch.zeros((n,) + src.shape[1:], dtype=src.dtype)
    return out.index_add_(0, seg, src)
def _pad(x, pw):
    flat = tuple(v for pair in reversed(pw) for v in pair)
    return torch.nn.functional.pad(x, flat)

kernel_name = 'concat_heads__mha_block_cached__gqa_block_cached__decode'

def setup_inputs():

    _w = (lambda a: (lambda t: t.to(torch.bfloat16) if t.is_floating_point() else t)(torch.as_tensor(a)))
    def _A_setup():
        B, Sq, D = 1, 1, 640
        H, Sk, Dh = 32, 4096, 192
        return {
            "x": _w((lambda *s: torch.randn(*s, dtype=torch.bfloat16) * 0.8)(B, Sq, D)),
            "k_cache": _w((lambda *s: torch.randn(*s, dtype=torch.bfloat16) * 0.8)(B, H, Sk, Dh)),
            "v_cache": _w((lambda *s: torch.randn(*s, dtype=torch.bfloat16) * 0.05)(B, H, Sk, Dh)),
            "wq": _w((lambda *s: torch.randn(*s, dtype=torch.bfloat16) * 0.8)(D, H * Dh) * (D ** -0.5)),
            "wo": _w((lambda *s: torch.randn(*s, dtype=torch.bfloat16) * 0.05)(H * Dh, D) * ((H * Dh) ** -0.5)),
        }
    _A_in = _A_setup()

    def _B_setup():
        B, Sq, D = 1, 1, 640
        Hq, Hkv, Sk, Dh = 32, 32, 4096, 192
        assert Hq % Hkv == 0, (Hq, Hkv)
        return {
            "x": _w((lambda *s: torch.randn(*s, dtype=torch.bfloat16) * 0.8)(B, Sq, D)),
            "k_cache": _w((lambda *s: torch.randn(*s, dtype=torch.bfloat16) * 0.8)(B, Hkv, Sk, Dh)),
            "v_cache": _w((lambda *s: torch.randn(*s, dtype=torch.bfloat16) * 0.05)(B, Hkv, Sk, Dh)),
            "wq": _w((lambda *s: torch.randn(*s, dtype=torch.bfloat16) * 0.8)(D, Hq * Dh) * (D ** -0.5)),
            "wo": _w((lambda *s: torch.randn(*s, dtype=torch.bfloat16) * 0.05)(Hq * Dh, D) * ((Hq * Dh) ** -0.5)),
        }
    _B_in = _B_setup()

    return {
        "A_x": _A_in["x"],
        "A_k_cache": _A_in["k_cache"],
        "A_v_cache": _A_in["v_cache"],
        "A_wq": _A_in["wq"],
        "A_wo": _A_in["wo"],
        "B_x": _B_in["x"],
        "B_k_cache": _B_in["k_cache"],
        "B_v_cache": _B_in["v_cache"],
        "B_wq": _B_in["wq"],
        "B_wo": _B_in["wo"],
    }

def reference(A_x, A_k_cache, A_v_cache, A_wq, A_wo, B_x, B_k_cache, B_v_cache, B_wq, B_wo):
    def _A_ref(x, k_cache, v_cache, wq, wo):
        B, Sq, D = x.shape
        H, Dh = 32, 192
        q = (lambda x, *d: x.permute(*d))((x @ wq).reshape(B, Sq, H, Dh), 0, 2, 1, 3)
        scores = torch.einsum("bhqd,bhkd->bhqk", q, k_cache) * (Dh ** -0.5)
        p = _softmax(scores, axis=-1)
        o = torch.einsum("bhqk,bhkd->bhqd", p, v_cache)
        return (lambda x, *d: x.permute(*d))(o, 0, 2, 1, 3).reshape(B, Sq, H * Dh) @ wo

    def _B_ref(x, k_cache, v_cache, wq, wo):
        B, Sq, D = x.shape
        Hq, Dh = 32, 192
        Hkv = k_cache.shape[1]
        rep = Hq // Hkv
        q = (lambda x, *d: x.permute(*d))((x @ wq).reshape(B, Sq, Hq, Dh), 0, 2, 1, 3)
        k = (lambda x, n, axis: torch.repeat_interleave(x, n, dim=axis))(k_cache, rep, axis=1)
        v = (lambda x, n, axis: torch.repeat_interleave(x, n, dim=axis))(v_cache, rep, axis=1)
        scores = torch.einsum("bhqd,bhkd->bhqk", q, k) * (Dh ** -0.5)
        p = _softmax(scores, axis=-1)
        o = torch.einsum("bhqk,bhkd->bhqd", p, v)
        return (lambda x, *d: x.permute(*d))(o, 0, 2, 1, 3).reshape(B, Sq, Hq * Dh) @ wo

    a = _A_ref(A_x, A_k_cache, A_v_cache, A_wq, A_wo)
    b = _B_ref(B_x, B_k_cache, B_v_cache, B_wq, B_wo)
    return torch.concatenate([a, b], axis=-1)
```

```asm
; @launch grid=(256,1,1) block=(1024,1,1) lds=24000
.amdgcn_target "amdgcn-amd-amdhsa--gfx950"
.text
.globl concat_heads__mha_block_cached__gqa_block_cached__decode_kernel
.p2align 8
.type concat_heads__mha_block_cached__gqa_block_cached__decode_kernel,@function
concat_heads__mha_block_cached__gqa_block_cached__decode_kernel:
    s_cmp_ge_u32 s2, 256
    s_cbranch_scc1 L_end
    s_load_dwordx16 s[4:19], s[0:1], 0
    s_load_dwordx8 s[20:27], s[0:1], 64
    s_load_dwordx2 s[28:29], s[0:1], 96
    v_lshrrev_b32 v6, 6, v0
    v_and_b32 v3, 7, v0
    v_readfirstlane_b32 s64, v6
    v_bfe_u32 v7, v0, 4, 2
    v_bfe_u32 v6, v0, 3, 1
    v_lshl_add_u32 v4, v6, 2, v7
    s_lshr_b32 s65, s2, 7
    s_and_b32 s69, s2, 7
    s_bfe_u32 s70, s2, 0x20005
    s_bfe_u32 s65, s2, 0x10002
    s_and_b32 s69, s2, 3
    s_lshl_b32 s69, s69, 3
    s_lshr_b32 s70, s2, 5
    s_or_b32 s66, s69, s70
    s_bfe_u32 s67, s2, 0x20003
    s_lshl_b32 s68, s65, 5
    s_add_u32 s68, s68, s66
    s_lshl_b32 s68, s68, 2
    s_add_u32 s68, s68, s67
    s_sub_u32 s93, s64, 0
    s_sub_u32 s76, s64, 4
    s_cmp_lt_u32 s93, 4
    s_cbranch_scc1 L_stream
    s_cmp_ge_u32 s76, 10
    s_cbranch_scc1 L_help
    v_lshlrev_b32 v6, 2, v4
    v_mul_u32_u24 v1, 24576, v4
    v_lshl_add_u32 v1, v3, 4, v1
    s_mul_i32 s71, s66, 384
    s_mul_i32 s70, s67, 10
    s_add_u32 s70, s70, s76
    s_mul_i32 s92, s70, 196608
    s_lshl_b32 s70, s70, 5
    s_add_u32 s72, s92, 12288
    s_waitcnt lgkmcnt(0)
    s_cmp_eq_u32 s65, 0
    s_cselect_b64 s[10:11], s[10:11], s[20:21]
    s_cselect_b64 s[4:5], s[4:5], s[14:15]
    s_cselect_b64 s[12:13], s[12:13], s[22:23]
    s_add_u32 s40, s10, s71
    s_addc_u32 s11, s11, 0
    s_sub_u32 s42, 7864320, s71
    s_and_b32 s41, s11, 0xffff
    s_mov_b32 s43, 0x20000
    s_mov_b32 s48, s4
    s_and_b32 s49, s5, 0xffff
    s_mov_b32 s50, 1280
    s_mov_b32 s51, 0x20000
    buffer_load_dwordx4 v[32:35], v1, s[40:43], s92 offen offset:0 nt
    buffer_load_dword v8, v6, s[48:51], s70 offen
    buffer_load_dwordx4 v[36:39], v1, s[40:43], s92 offen offset:128 nt
    buffer_load_dwordx4 v[40:43], v1, s[40:43], s92 offen offset:256 nt
    buffer_load_dwordx4 v[44:47], v1, s[40:43], s72 offen offset:0 nt
    buffer_load_dwordx4 v[48:51], v1, s[40:43], s72 offen offset:128 nt
    buffer_load_dwordx4 v[52:55], v1, s[40:43], s72 offen offset:256 nt
    s_barrier
    s_mov_b32 s52, s28
    s_and_b32 s53, s29, 0xffff
    s_mov_b32 s54, 917504
    s_mov_b32 s55, 0x20000
    s_mov_b32 s56, s24
    s_and_b32 s57, s25, 0xffff
    s_mov_b32 s58, 2560
    s_mov_b32 s59, 0x20000
    s_mov_b32 s60, s26
    s_and_b32 s61, s27, 0xffff
    s_mov_b32 s62, 256
    s_mov_b32 s63, 0x20000
    s_bfe_u32 s97, s2, 0x10002
    s_xor_b32 s97, s97, 1
    s_lshr_b32 s98, s2, 3
    s_lshl_b32 s98, s98, 2
    s_and_b32 s99, s2, 3
    s_add_u32 s98, s98, s99
    s_lshl_b32 s98, s98, 6
    s_mul_i32 s96, s97, 327680
    s_add_u32 s96, s96, s98
    s_mul_i32 s99, s97, 1280
    s_add_u32 s98, s98, s99
    s_lshl_b32 s97, s97, 10
    s_add_u32 s97, s97, 655360
    s_mov_b32 s99, 0
    v_and_b32 v6, 1, v0
    v_lshlrev_b32 v6, 4, v6
    v_mov_b32 v7, 0xffff
    v_lshlrev_b32 v6, v6, v7
    v_lshrrev_b32 v7, 1, v3
    v_cmp_eq_u32 vcc, 0, v7
    s_nop 1
    v_cndmask_b32 v12, 0, v6, vcc
    v_cmp_eq_u32 vcc, 1, v7
    s_nop 1
    v_cndmask_b32 v13, 0, v6, vcc
    v_cmp_eq_u32 vcc, 2, v7
    s_nop 1
    v_cndmask_b32 v14, 0, v6, vcc
    v_cmp_eq_u32 vcc, 3, v7
    s_nop 1
    v_cndmask_b32 v15, 0, v6, vcc
    s_mul_i32 s69, s76, 1536
    s_add_u32 s69, s69, 0
    v_lshrrev_b32 v6, 2, v4
    v_mul_u32_u24 v2, 768, v6
    v_and_b32 v6, 1, v4
    v_lshl_add_u32 v2, v6, 7, v2
    v_lshl_add_u32 v2, v3, 4, v2
    v_add_u32 v2, s69, v2
    s_mov_b32 s78, 0x00ff00ff
    s_mov_b32 s79, 0xff00ff00
    s_mov_b32 s84, 0x01000100
    s_mov_b32 s85, 0x03020302
    s_mul_i32 s69, s66, 245760
    s_add_u32 s12, s12, s69
    s_addc_u32 s13, s13, 0
    s_mov_b32 s44, s12
    s_and_b32 s45, s13, 0xffff
    s_mov_b32 s46, 245760
    s_mov_b32 s47, 0x20000
    s_waitcnt vmcnt(3)
    v_perm_b32 v6, v8, v8, s84
    v_and_b32 v28, v12, v6
    v_and_b32 v29, v13, v6
    v_and_b32 v30, v14, v6
    v_and_b32 v31, v15, v6
    s_nop 1
    v_mfma_f32_16x16x32_bf16 v[16:19], v[32:35], v[28:31], 0
    v_mfma_f32_16x16x32_bf16 v[20:23], v[36:39], v[28:31], 0
    v_mfma_f32_16x16x32_bf16 v[24:27], v[40:43], v[28:31], 0
    s_waitcnt vmcnt(0)
    v_perm_b32 v6, v8, v8, s85
    v_and_b32 v28, v12, v6
    v_and_b32 v29, v13, v6
    v_and_b32 v30, v14, v6
    v_and_b32 v31, v15, v6
    s_nop 1
    v_mfma_f32_16x16x32_bf16 v[16:19], v[44:47], v[28:31], v[16:19]
    v_mfma_f32_16x16x32_bf16 v[20:23], v[48:51], v[28:31], v[20:23]
    v_mfma_f32_16x16x32_bf16 v[24:27], v[52:55], v[28:31], v[24:27]
    v_bfe_u32 v6, v0, 4, 1
    v_bfe_u32 v7, v0, 5, 1
    v_lshl_add_u32 v6, v6, 4, v7
    v_mul_u32_u24 v1, 1280, v6
    v_and_b32 v7, 15, v0
    v_lshl_add_u32 v1, v7, 4, v1
    s_and_b32 s69, s76, 1
    s_lshr_b32 s70, s76, 1
    s_mul_i32 s92, s69, 40960
    s_lshl_b32 s71, s70, 8
    s_add_u32 s92, s92, s71
    s_mov_b64 exec, s[78:79]
    ds_write_b128 v2, v[16:19] offset:0
    ds_write_b128 v2, v[20:23] offset:256
    ds_write_b128 v2, v[24:27] offset:512
    s_mov_b64 exec, -1
    v_mov_b32 v8, 0
    v_mov_b32 v9, 1
    s_mov_b64 exec, 1
    ds_add_u32 v8, v9 offset:21920
    s_mov_b64 exec, -1
    s_mul_i32 s90, s68, 2560
    s_mul_i32 s72, s69, 1280
    s_add_u32 s90, s90, s72
    s_add_u32 s90, s90, s71
    v_bfe_u32 v6, v0, 4, 2
    v_lshlrev_b32 v4, 4, v7
    v_add_u32 v3, s67, v7
    v_bfi_b32 v7, 3, v3, v7
    v_and_b32 v3, 12, v7
    v_add_u32 v7, v7, v3
    v_lshl_add_u32 v6, v7, 2, v6
    s_mul_i32 s69, s69, 128
    v_lshl_add_u32 v3, v6, 3, s69
    s_mov_b32 s84, 0x05040100
    s_mov_b32 s85, 0x07060302
    s_add_u32 s69, s67, 0
    s_and_b32 s69, s69, 3
    s_mul_i32 s69, s69, 2560
    s_add_u32 s69, s69, s92
    s_add_u32 s72, s69, 0
    buffer_load_dwordx4 v[32:35], v1, s[44:47], s72 offen
    s_waitcnt vmcnt(0)
    s_add_u32 s72, s69, 10240
    buffer_load_dwordx4 v[36:39], v1, s[44:47], s72 offen
    s_waitcnt vmcnt(0)
    s_add_u32 s72, s69, 81920
    buffer_load_dwordx4 v[64:67], v1, s[44:47], s72 offen
    s_waitcnt vmcnt(0)
    s_add_u32 s72, s69, 92160
    buffer_load_dwordx4 v[68:71], v1, s[44:47], s72 offen
    s_waitcnt vmcnt(0)
    s_add_u32 s72, s69, 163840
    buffer_load_dwordx4 v[96:99], v1, s[44:47], s72 offen
    s_waitcnt vmcnt(0)
    s_add_u32 s72, s69, 174080
    buffer_load_dwordx4 v[100:103], v1, s[44:47], s72 offen
    s_add_u32 s69, s67, 1
    s_and_b32 s69, s69, 3
    s_mul_i32 s69, s69, 2560
    s_add_u32 s69, s69, s92
    s_waitcnt vmcnt(0)
    s_add_u32 s72, s69, 0
    buffer_load_dwordx4 v[40:43], v1, s[44:47], s72 offen
    s_waitcnt vmcnt(0)
    s_add_u32 s72, s69, 10240
    buffer_load_dwordx4 v[44:47], v1, s[44:47], s72 offen
    s_waitcnt vmcnt(0)
    s_add_u32 s72, s69, 81920
    buffer_load_dwordx4 v[72:75], v1, s[44:47], s72 offen
    s_waitcnt vmcnt(0)
    s_add_u32 s72, s69, 92160
    buffer_load_dwordx4 v[76:79], v1, s[44:47], s72 offen
    s_waitcnt vmcnt(0)
    s_add_u32 s72, s69, 163840
    buffer_load_dwordx4 v[104:107], v1, s[44:47], s72 offen
    s_waitcnt vmcnt(0)
    s_add_u32 s72, s69, 174080
    buffer_load_dwordx4 v[108:111], v1, s[44:47], s72 offen
    s_add_u32 s69, s67, 2
    s_and_b32 s69, s69, 3
    s_mul_i32 s69, s69, 2560
    s_add_u32 s69, s69, s92
    s_waitcnt vmcnt(0)
    s_add_u32 s72, s69, 0
    buffer_load_dwordx4 v[48:51], v1, s[44:47], s72 offen
    s_waitcnt vmcnt(0)
    s_add_u32 s72, s69, 10240
    buffer_load_dwordx4 v[52:55], v1, s[44:47], s72 offen
    s_waitcnt vmcnt(0)
    s_add_u32 s72, s69, 81920
    buffer_load_dwordx4 v[80:83], v1, s[44:47], s72 offen
    s_waitcnt vmcnt(0)
    s_add_u32 s72, s69, 92160
    buffer_load_dwordx4 v[84:87], v1, s[44:47], s72 offen
    s_waitcnt vmcnt(0)
    s_add_u32 s72, s69, 163840
    buffer_load_dwordx4 v[112:115], v1, s[44:47], s72 offen
    s_waitcnt vmcnt(0)
    s_add_u32 s72, s69, 174080
    buffer_load_dwordx4 v[116:119], v1, s[44:47], s72 offen
    s_add_u32 s69, s67, 3
    s_and_b32 s69, s69, 3
    s_mul_i32 s69, s69, 2560
    s_add_u32 s69, s69, s92
    s_waitcnt vmcnt(0)
    s_add_u32 s72, s69, 0
    buffer_load_dwordx4 v[56:59], v1, s[44:47], s72 offen
    s_waitcnt vmcnt(0)
    s_add_u32 s72, s69, 10240
    buffer_load_dwordx4 v[60:63], v1, s[44:47], s72 offen
    s_waitcnt vmcnt(0)
    s_add_u32 s72, s69, 81920
    buffer_load_dwordx4 v[88:91], v1, s[44:47], s72 offen
    s_waitcnt vmcnt(0)
    s_add_u32 s72, s69, 92160
    buffer_load_dwordx4 v[92:95], v1, s[44:47], s72 offen
    s_waitcnt vmcnt(0)
    s_add_u32 s72, s69, 163840
    buffer_load_dwordx4 v[120:123], v1, s[44:47], s72 offen
    s_waitcnt vmcnt(0)
    s_add_u32 s72, s69, 174080
    buffer_load_dwordx4 v[124:127], v1, s[44:47], s72 offen
    s_waitcnt vmcnt(4)
    v_perm_b32 v8, v36, v32, s84
    v_perm_b32 v36, v36, v32, s85
    v_mov_b32 v32, v8
    v_perm_b32 v8, v37, v33, s84
    v_perm_b32 v9, v37, v33, s85
    v_perm_b32 v33, v44, v40, s84
    v_perm_b32 v37, v44, v40, s85
    v_mov_b32 v40, v8
    v_mov_b32 v44, v9
    v_perm_b32 v8, v38, v34, s84
    v_perm_b32 v9, v38, v34, s85
    v_perm_b32 v34, v52, v48, s84
    v_perm_b32 v38, v52, v48, s85
    v_mov_b32 v48, v8
    v_mov_b32 v52, v9
    v_perm_b32 v8, v39, v35, s84
    v_perm_b32 v9, v39, v35, s85
    v_perm_b32 v35, v60, v56, s84
    v_perm_b32 v39, v60, v56, s85
    v_mov_b32 v56, v8
    v_mov_b32 v60, v9
    v_perm_b32 v8, v45, v41, s84
    v_perm_b32 v45, v45, v41, s85
    v_mov_b32 v41, v8
    v_perm_b32 v8, v46, v42, s84
    v_perm_b32 v9, v46, v42, s85
    v_perm_b32 v42, v53, v49, s84
    v_perm_b32 v46, v53, v49, s85
    v_mov_b32 v49, v8
    v_mov_b32 v53, v9
    v_perm_b32 v8, v47, v43, s84
    v_perm_b32 v9, v47, v43, s85
    v_perm_b32 v43, v61, v57, s84
    v_perm_b32 v47, v61, v57, s85
    v_mov_b32 v57, v8
    v_mov_b32 v61, v9
    v_perm_b32 v8, v54, v50, s84
    v_perm_b32 v54, v54, v50, s85
    v_mov_b32 v50, v8
    v_perm_b32 v8, v55, v51, s84
    v_perm_b32 v9, v55, v51, s85
    v_perm_b32 v51, v62, v58, s84
    v_perm_b32 v55, v62, v58, s85
    v_mov_b32 v58, v8
    v_mov_b32 v62, v9
    v_perm_b32 v8, v63, v59, s84
    v_perm_b32 v63, v63, v59, s85
    v_mov_b32 v59, v8
    s_waitcnt vmcnt(2)
    v_perm_b32 v8, v68, v64, s84
    v_perm_b32 v68, v68, v64, s85
    v_mov_b32 v64, v8
    v_perm_b32 v8, v69, v65, s84
    v_perm_b32 v9, v69, v65, s85
    v_perm_b32 v65, v76, v72, s84
    v_perm_b32 v69, v76, v72, s85
    v_mov_b32 v72, v8
    v_mov_b32 v76, v9
    v_perm_b32 v8, v70, v66, s84
    v_perm_b32 v9, v70, v66, s85
    v_perm_b32 v66, v84, v80, s84
    v_perm_b32 v70, v84, v80, s85
    v_mov_b32 v80, v8
    v_mov_b32 v84, v9
    v_perm_b32 v8, v71, v67, s84
    v_perm_b32 v9, v71, v67, s85
    v_perm_b32 v67, v92, v88, s84
    v_perm_b32 v71, v92, v88, s85
    v_mov_b32 v88, v8
    v_mov_b32 v92, v9
    v_perm_b32 v8, v77, v73, s84
    v_perm_b32 v77, v77, v73, s85
    v_mov_b32 v73, v8
    v_perm_b32 v8, v78, v74, s84
    v_perm_b32 v9, v78, v74, s85
    v_perm_b32 v74, v85, v81, s84
    v_perm_b32 v78, v85, v81, s85
    v_mov_b32 v81, v8
    v_mov_b32 v85, v9
    v_perm_b32 v8, v79, v75, s84
    v_perm_b32 v9, v79, v75, s85
    v_perm_b32 v75, v93, v89, s84
    v_perm_b32 v79, v93, v89, s85
    v_mov_b32 v89, v8
    v_mov_b32 v93, v9
    v_perm_b32 v8, v86, v82, s84
    v_perm_b32 v86, v86, v82, s85
    v_mov_b32 v82, v8
    v_perm_b32 v8, v87, v83, s84
    v_perm_b32 v9, v87, v83, s85
    v_perm_b32 v83, v94, v90, s84
    v_perm_b32 v87, v94, v90, s85
    v_mov_b32 v90, v8
    v_mov_b32 v94, v9
    v_perm_b32 v8, v95, v91, s84
    v_perm_b32 v95, v95, v91, s85
    v_mov_b32 v91, v8
    s_waitcnt vmcnt(0)
    v_perm_b32 v8, v100, v96, s84
    v_perm_b32 v100, v100, v96, s85
    v_mov_b32 v96, v8
    v_perm_b32 v8, v101, v97, s84
    v_perm_b32 v9, v101, v97, s85
    v_perm_b32 v97, v108, v104, s84
    v_perm_b32 v101, v108, v104, s85
    v_mov_b32 v104, v8
    v_mov_b32 v108, v9
    v_perm_b32 v8, v102, v98, s84
    v_perm_b32 v9, v102, v98, s85
    v_perm_b32 v98, v116, v112, s84
    v_perm_b32 v102, v116, v112, s85
    v_mov_b32 v112, v8
    v_mov_b32 v116, v9
    v_perm_b32 v8, v103, v99, s84
    v_perm_b32 v9, v103, v99, s85
    v_perm_b32 v99, v124, v120, s84
    v_perm_b32 v103, v124, v120, s85
    v_mov_b32 v120, v8
    v_mov_b32 v124, v9
    v_perm_b32 v8, v109, v105, s84
    v_perm_b32 v109, v109, v105, s85
    v_mov_b32 v105, v8
    v_perm_b32 v8, v110, v106, s84
    v_perm_b32 v9, v110, v106, s85
    v_perm_b32 v106, v117, v113, s84
    v_perm_b32 v110, v117, v113, s85
    v_mov_b32 v113, v8
    v_mov_b32 v117, v9
    v_perm_b32 v8, v111, v107, s84
    v_perm_b32 v9, v111, v107, s85
    v_perm_b32 v107, v125, v121, s84
    v_perm_b32 v111, v125, v121, s85
    v_mov_b32 v121, v8
    v_mov_b32 v125, v9
    v_perm_b32 v8, v118, v114, s84
    v_perm_b32 v118, v118, v114, s85
    v_mov_b32 v114, v8
    v_perm_b32 v8, v119, v115, s84
    v_perm_b32 v9, v119, v115, s85
    v_perm_b32 v115, v126, v122, s84
    v_perm_b32 v119, v126, v122, s85
    v_mov_b32 v122, v8
    v_mov_b32 v126, v9
    v_perm_b32 v8, v127, v123, s84
    v_perm_b32 v127, v127, v123, s85
    v_mov_b32 v123, v8
    v_and_b32 v6, 3, v0
    v_lshlrev_b32 v6, 3, v6
    s_barrier
    ds_read_b64 v[8:9], v6 offset:21888
    s_waitcnt lgkmcnt(0)
    v_max_f32_dpp v10, v8, v8 quad_perm:[1,0,3,2] row_mask:0xf bank_mask:0xf
    s_nop 1
    v_max_f32_dpp v10, v10, v10 quad_perm:[2,3,0,1] row_mask:0xf bank_mask:0xf
    v_sub_f32 v8, v8, v10
    v_exp_f32 v8, v8
    s_nop 0
    v_readlane_b32 s80, v8, 0
    v_readlane_b32 s81, v8, 1
    v_readlane_b32 s82, v8, 2
    v_readlane_b32 s83, v8, 3
    s_mov_b32 exec_lo, 0xff00ff
    s_mov_b32 exec_hi, 0xff00ff
    s_barrier
    ds_read_b64 v[16:17], v3 offset:15360
    ds_read_b64 v[18:19], v3 offset:16128
    ds_read_b64 v[20:21], v3 offset:16896
    ds_read_b64 v[22:23], v3 offset:17664
    ds_read_b64 v[24:25], v3 offset:18432
    ds_read_b64 v[26:27], v3 offset:19200
    ds_read_b64 v[28:29], v3 offset:19968
    ds_read_b64 v[30:31], v3 offset:20736
    s_mov_b64 exec, -1
    s_waitcnt lgkmcnt(6)
    v_add_f32 v16, v16, v18
    v_add_f32 v17, v17, v19
    v_mul_f32 v6, s80, v16
    v_mul_f32 v7, s80, v17
    s_waitcnt lgkmcnt(4)
    v_add_f32 v20, v20, v22
    v_add_f32 v21, v21, v23
    v_fmac_f32 v6, s81, v20
    v_fmac_f32 v7, s81, v21
    s_waitcnt lgkmcnt(2)
    v_add_f32 v24, v24, v26
    v_add_f32 v25, v25, v27
    v_fmac_f32 v6, s82, v24
    v_fmac_f32 v7, s82, v25
    s_waitcnt lgkmcnt(0)
    v_add_f32 v28, v28, v30
    v_add_f32 v29, v29, v31
    v_fmac_f32 v6, s83, v28
    v_fmac_f32 v7, s83, v29
    v_cvt_pk_bf16_f32 v6, v6, v7
    s_nop 1
    v_mov_b32_dpp v16, v6 row_newbcast:0 row_mask:0xf bank_mask:0xf
    v_mov_b32_dpp v17, v6 row_newbcast:1 row_mask:0xf bank_mask:0xf
    v_mov_b32_dpp v18, v6 row_newbcast:2 row_mask:0xf bank_mask:0xf
    v_mov_b32_dpp v19, v6 row_newbcast:3 row_mask:0xf bank_mask:0xf
    v_mov_b32_dpp v20, v6 row_newbcast:4 row_mask:0xf bank_mask:0xf
    v_mov_b32_dpp v21, v6 row_newbcast:5 row_mask:0xf bank_mask:0xf
    v_mfma_f32_16x16x32_bf16 v[8:11], v[16:19], v[32:35], 0
    v_mov_b32_dpp v22, v6 row_newbcast:6 row_mask:0xf bank_mask:0xf
    v_mfma_f32_16x16x32_bf16 v[12:15], v[16:19], v[36:39], 0
    v_mov_b32_dpp v23, v6 row_newbcast:7 row_mask:0xf bank_mask:0xf
    v_mfma_f32_16x16x32_bf16 v[32:35], v[16:19], v[40:43], 0
    v_mfma_f32_16x16x32_bf16 v[36:39], v[16:19], v[44:47], 0
    v_mfma_f32_16x16x32_bf16 v[40:43], v[16:19], v[48:51], 0
    v_mfma_f32_16x16x32_bf16 v[44:47], v[16:19], v[52:55], 0
    v_mfma_f32_16x16x32_bf16 v[48:51], v[16:19], v[56:59], 0
    v_mfma_f32_16x16x32_bf16 v[52:55], v[16:19], v[60:63], 0
    v_mfma_f32_16x16x32_bf16 v[8:11], v[20:23], v[64:67], v[8:11]
    v_mfma_f32_16x16x32_bf16 v[12:15], v[20:23], v[68:71], v[12:15]
    v_mfma_f32_16x16x32_bf16 v[32:35], v[20:23], v[72:75], v[32:35]
    v_mfma_f32_16x16x32_bf16 v[36:39], v[20:23], v[76:79], v[36:39]
    v_mfma_f32_16x16x32_bf16 v[40:43], v[20:23], v[80:83], v[40:43]
    v_mfma_f32_16x16x32_bf16 v[44:47], v[20:23], v[84:87], v[44:47]
    v_mfma_f32_16x16x32_bf16 v[48:51], v[20:23], v[88:91], v[48:51]
    v_mfma_f32_16x16x32_bf16 v[52:55], v[20:23], v[92:95], v[52:55]
    v_lshrrev_b32 v56, 3, v0
    v_mul_u32_u24 v56, 2560, v56
    v_bfe_u32 v60, v0, 2, 1
    v_mul_u32_u24 v60, 1280, v60
    v_add_u32 v56, v56, v60
    v_and_b32 v60, 3, v0
    v_lshl_add_u32 v56, v60, 4, v56
    s_mov_b32 s99, 1
    s_cmp_ge_u32 s2, 40
    s_mov_b32 exec_lo, 0xf000f00
    s_mov_b32 exec_hi, 0xf000f00
    s_barrier
    ds_read_b64 v[16:17], v3 offset:15360
    ds_read_b64 v[18:19], v3 offset:16128
    ds_read_b64 v[20:21], v3 offset:16896
    ds_read_b64 v[22:23], v3 offset:17664
    ds_read_b64 v[24:25], v3 offset:18432
    ds_read_b64 v[26:27], v3 offset:19200
    ds_read_b64 v[28:29], v3 offset:19968
    ds_read_b64 v[30:31], v3 offset:20736
    s_mov_b64 exec, -1
    s_cbranch_scc1 L_ay
    buffer_load_dwordx4 v[64:67], v56, s[52:55], s96 offen sc1
L_ay:
    s_waitcnt lgkmcnt(6)
    v_add_f32 v16, v16, v18
    v_add_f32 v17, v17, v19
    v_mul_f32 v6, s80, v16
    v_mul_f32 v7, s80, v17
    s_waitcnt lgkmcnt(4)
    v_add_f32 v20, v20, v22
    v_add_f32 v21, v21, v23
    v_fmac_f32 v6, s81, v20
    v_fmac_f32 v7, s81, v21
    s_waitcnt lgkmcnt(2)
    v_add_f32 v24, v24, v26
    v_add_f32 v25, v25, v27
    v_fmac_f32 v6, s82, v24
    v_fmac_f32 v7, s82, v25
    s_waitcnt lgkmcnt(0)
    v_add_f32 v28, v28, v30
    v_add_f32 v29, v29, v31
    v_fmac_f32 v6, s83, v28
    v_fmac_f32 v7, s83, v29
    v_cvt_pk_bf16_f32 v6, v6, v7
    s_nop 1
    v_mov_b32_dpp v24, v6 row_newbcast:8 row_mask:0xf bank_mask:0xf
    v_mov_b32_dpp v25, v6 row_newbcast:9 row_mask:0xf bank_mask:0xf
    v_mov_b32_dpp v26, v6 row_newbcast:10 row_mask:0xf bank_mask:0xf
    v_mov_b32_dpp v27, v6 row_newbcast:11 row_mask:0xf bank_mask:0xf
    s_nop 1
    v_mfma_f32_16x16x32_bf16 v[8:11], v[24:27], v[96:99], v[8:11]
    v_mfma_f32_16x16x32_bf16 v[12:15], v[24:27], v[100:103], v[12:15]
    v_mfma_f32_16x16x32_bf16 v[32:35], v[24:27], v[104:107], v[32:35]
    v_mfma_f32_16x16x32_bf16 v[36:39], v[24:27], v[108:111], v[36:39]
    v_mfma_f32_16x16x32_bf16 v[40:43], v[24:27], v[112:115], v[40:43]
    v_mfma_f32_16x16x32_bf16 v[44:47], v[24:27], v[116:119], v[44:47]
    v_mfma_f32_16x16x32_bf16 v[48:51], v[24:27], v[120:123], v[48:51]
    v_mfma_f32_16x16x32_bf16 v[52:55], v[24:27], v[124:127], v[52:55]
    s_nop 2
    v_cvt_pk_bf16_f32 v28, v8, v12
    v_cvt_pk_bf16_f32 v29, v32, v36
    s_mov_b64 exec, 0xffff
    v_cvt_pk_bf16_f32 v30, v40, v44
    v_min_u32 v28, -2, v28
    v_cvt_pk_bf16_f32 v31, v48, v52
    v_min_u32 v29, -2, v29
    v_min_u32 v30, -2, v30
    v_min_u32 v31, -2, v31
    buffer_store_dwordx4 v[28:31], v4, s[52:55], s90 offen sc1
    s_mov_b64 exec, -1
    s_cbranch_scc1 L_fin
    s_branch L_b5
L_stream:
    s_setprio 3
    v_mul_u32_u24 v1, 384, v4
    v_lshl_add_u32 v1, v3, 4, v1
    s_mul_i32 s69, s93, 98304
    v_add_u32 v1, s69, v1
    s_mul_i32 s69, s66, 1572864
    s_mul_i32 s70, s67, 393216
    s_add_u32 s69, s69, s70
    s_waitcnt lgkmcnt(0)
    s_cmp_eq_u32 s65, 0
    s_cselect_b64 s[6:7], s[6:7], s[16:17]
    s_cselect_b64 s[8:9], s[8:9], s[18:19]
    s_add_u32 s6, s6, s69
    s_addc_u32 s7, s7, 0
    s_mov_b32 s32, s6
    s_and_b32 s33, s7, 0xffff
    s_mov_b32 s34, 393216
    s_mov_b32 s35, 0x20000
    buffer_load_dwordx4 v[56:59], v1, s[32:35], 0 offen offset:0 nt
    buffer_load_dwordx4 v[60:63], v1, s[32:35], 0 offen offset:128 nt
    buffer_load_dwordx4 v[64:67], v1, s[32:35], 0 offen offset:256 nt
    s_mov_b32 s72, 3072
    buffer_load_dwordx4 v[68:71], v1, s[32:35], s72 offen offset:0 nt
    s_add_u32 s8, s8, s69
    s_addc_u32 s9, s9, 0
    s_mov_b32 s36, s8
    s_and_b32 s37, s9, 0xffff
    s_mov_b32 s38, 393216
    s_mov_b32 s39, 0x20000
    s_barrier
    s_mov_b32 s52, s28
    s_and_b32 s53, s29, 0xffff
    s_mov_b32 s54, 917504
    s_mov_b32 s55, 0x20000
    s_mov_b32 s56, s24
    s_and_b32 s57, s25, 0xffff
    s_mov_b32 s58, 2560
    s_mov_b32 s59, 0x20000
    s_mov_b32 s60, s26
    s_and_b32 s61, s27, 0xffff
    s_mov_b32 s62, 256
    s_mov_b32 s63, 0x20000
    s_bfe_u32 s97, s2, 0x10002
    s_xor_b32 s97, s97, 1
    s_lshr_b32 s98, s2, 3
    s_lshl_b32 s98, s98, 2
    s_and_b32 s99, s2, 3
    s_add_u32 s98, s98, s99
    s_lshl_b32 s98, s98, 6
    s_mul_i32 s96, s97, 327680
    s_add_u32 s96, s96, s98
    s_mul_i32 s99, s97, 1280
    s_add_u32 s98, s98, s99
    s_lshl_b32 s97, s97, 10
    s_add_u32 s97, s97, 655360
    s_mov_b32 s99, 0
    v_and_b32 v6, 1, v0
    v_lshlrev_b32 v6, 4, v6
    v_mov_b32 v7, 0xffff
    v_lshlrev_b32 v6, v6, v7
    v_lshrrev_b32 v7, 1, v3
    v_cmp_eq_u32 vcc, 0, v7
    s_nop 1
    v_cndmask_b32 v12, 0, v6, vcc
    v_cmp_eq_u32 vcc, 1, v7
    s_nop 1
    v_cndmask_b32 v13, 0, v6, vcc
    v_cmp_eq_u32 vcc, 2, v7
    s_nop 1
    v_cndmask_b32 v14, 0, v6, vcc
    v_cmp_eq_u32 vcc, 3, v7
    s_nop 1
    v_cndmask_b32 v15, 0, v6, vcc
    s_mul_i32 s69, s93, 1536
    s_add_u32 s69, s69, 15360
    v_lshrrev_b32 v6, 2, v4
    v_mul_u32_u24 v2, 768, v6
    v_and_b32 v6, 1, v4
    v_lshl_add_u32 v2, v6, 7, v2
    v_lshl_add_u32 v2, v3, 4, v2
    v_add_u32 v2, s69, v2
    s_mov_b32 s78, 0x00ff00ff
    s_mov_b32 s79, 0xff00ff00
    s_mov_b32 s73, 0x3dd53b95
    s_mov_b32 s31, 0
    s_mov_b64 vcc, 0
    s_waitcnt vmcnt(3)
    buffer_load_dwordx4 v[72:75], v1, s[32:35], s72 offen offset:128 nt
    s_waitcnt vmcnt(3)
    buffer_load_dwordx4 v[76:79], v1, s[32:35], s72 offen offset:256 nt
    s_waitcnt vmcnt(3)
    s_mov_b32 s72, 6144
    buffer_load_dwordx4 v[80:83], v1, s[32:35], s72 offen offset:0 nt
    s_waitcnt vmcnt(3)
    buffer_load_dwordx4 v[84:87], v1, s[32:35], s72 offen offset:128 nt
    s_waitcnt vmcnt(3)
    buffer_load_dwordx4 v[88:91], v1, s[32:35], s72 offen offset:256 nt
    s_waitcnt vmcnt(3)
    s_mov_b32 s72, 9216
    buffer_load_dwordx4 v[92:95], v1, s[32:35], s72 offen offset:0 nt
    s_waitcnt vmcnt(3)
    buffer_load_dwordx4 v[96:99], v1, s[32:35], s72 offen offset:128 nt
    s_waitcnt vmcnt(3)
    buffer_load_dwordx4 v[100:103], v1, s[32:35], s72 offen offset:256 nt
    s_waitcnt vmcnt(3)
    s_mov_b32 s72, 12288
    buffer_load_dwordx4 v[104:107], v1, s[32:35], s72 offen offset:0 nt
    s_waitcnt vmcnt(3)
    buffer_load_dwordx4 v[108:111], v1, s[32:35], s72 offen offset:128 nt
    s_waitcnt vmcnt(3)
    buffer_load_dwordx4 v[112:115], v1, s[32:35], s72 offen offset:256 nt
    s_waitcnt vmcnt(3)
    s_mov_b32 s72, 15360
    buffer_load_dwordx4 v[116:119], v1, s[32:35], s72 offen offset:0 nt
    s_waitcnt vmcnt(3)
    buffer_load_dwordx4 v[120:123], v1, s[32:35], s72 offen offset:128 nt
    s_waitcnt vmcnt(3)
    buffer_load_dwordx4 v[124:127], v1, s[32:35], s72 offen offset:256 nt
    v_lshlrev_b32 v6, 4, v3
    v_mov_b32 v7, 0
    s_mov_b32 s77, 0
L_qwait:
    ds_read_b32 v49, v7 offset:21924
    ds_read_b128 v[36:39], v6 offset:21504
    ds_read_b128 v[40:43], v6 offset:21632
    ds_read_b128 v[44:47], v6 offset:21760
    s_add_u32 s77, s77, 1
    s_waitcnt lgkmcnt(0)
    v_readfirstlane_b32 s69, v49
    s_cmp_ge_u32 s77, 0x40000
    s_cbranch_scc1 L_qok
    s_cmp_eq_u32 s69, 0
    s_cbranch_scc1 L_qwait
L_qok:
    s_waitcnt vmcnt(3)
    v_mov_b32 v28, 0
    v_dot2c_f32_bf16 v28, v56, v36
    v_dot2c_f32_bf16 v28, v57, v37
    v_dot2c_f32_bf16 v28, v58, v38
    v_dot2c_f32_bf16 v28, v59, v39
    s_mov_b32 s72, 18432
    buffer_load_dwordx4 v[56:59], v1, s[32:35], s72 offen offset:0 nt
    v_dot2c_f32_bf16 v28, v60, v40
    v_dot2c_f32_bf16 v28, v61, v41
    v_dot2c_f32_bf16 v28, v62, v42
    v_dot2c_f32_bf16 v28, v63, v43
    buffer_load_dwordx4 v[60:63], v1, s[32:35], s72 offen offset:128 nt
    v_dot2c_f32_bf16 v28, v64, v44
    v_dot2c_f32_bf16 v28, v65, v45
    v_dot2c_f32_bf16 v28, v66, v46
    v_dot2c_f32_bf16 v28, v67, v47
    s_waitcnt vmcnt(4)
    buffer_load_dwordx4 v[64:67], v1, s[32:35], s72 offen offset:256 nt
    v_mov_b32 v29, 0
    v_dot2c_f32_bf16 v29, v68, v36
    v_dot2c_f32_bf16 v29, v69, v37
    v_dot2c_f32_bf16 v29, v70, v38
    v_dot2c_f32_bf16 v29, v71, v39
    s_waitcnt vmcnt(4)
    v_mov_b32 v3, 1
    v_and_b32 v4, 63, v0
    v_lshlrev_b32 v4, 2, v4
    ds_add_u32 v4, v3 offset:21952
    s_mov_b32 s72, 21504
    buffer_load_dwordx4 v[68:71], v1, s[32:35], s72 offen offset:0 nt
    v_dot2c_f32_bf16 v29, v72, v40
    v_dot2c_f32_bf16 v29, v73, v41
    v_dot2c_f32_bf16 v29, v74, v42
    v_dot2c_f32_bf16 v29, v75, v43
    s_waitcnt vmcnt(4)
    buffer_load_dwordx4 v[72:75], v1, s[32:35], s72 offen offset:128 nt
    v_dot2c_f32_bf16 v29, v76, v44
    v_dot2c_f32_bf16 v29, v77, v45
    v_dot2c_f32_bf16 v29, v78, v46
    v_dot2c_f32_bf16 v29, v79, v47
    v_mov_b32 v30, 0
    v_dot2c_f32_bf16 v30, v80, v36
    v_dot2c_f32_bf16 v30, v81, v37
    v_dot2c_f32_bf16 v30, v82, v38
    v_dot2c_f32_bf16 v30, v83, v39
    v_dot2c_f32_bf16 v30, v84, v40
    v_dot2c_f32_bf16 v30, v85, v41
    v_dot2c_f32_bf16 v30, v86, v42
    v_dot2c_f32_bf16 v30, v87, v43
    v_dot2c_f32_bf16 v30, v88, v44
    v_dot2c_f32_bf16 v30, v89, v45
    v_dot2c_f32_bf16 v30, v90, v46
    v_dot2c_f32_bf16 v30, v91, v47
    v_mov_b32 v31, 0
    v_dot2c_f32_bf16 v31, v92, v36
    v_dot2c_f32_bf16 v31, v93, v37
    v_dot2c_f32_bf16 v31, v94, v38
    v_dot2c_f32_bf16 v31, v95, v39
    v_dot2c_f32_bf16 v31, v96, v40
    v_dot2c_f32_bf16 v31, v97, v41
    v_dot2c_f32_bf16 v31, v98, v42
    v_dot2c_f32_bf16 v31, v99, v43
    v_dot2c_f32_bf16 v31, v100, v44
    v_dot2c_f32_bf16 v31, v101, v45
    v_dot2c_f32_bf16 v31, v102, v46
    v_dot2c_f32_bf16 v31, v103, v47
    v_mov_b32 v32, 0
    v_dot2c_f32_bf16 v32, v104, v36
    v_dot2c_f32_bf16 v32, v105, v37
    v_dot2c_f32_bf16 v32, v106, v38
    v_dot2c_f32_bf16 v32, v107, v39
    v_dot2c_f32_bf16 v32, v108, v40
    v_dot2c_f32_bf16 v32, v109, v41
    v_dot2c_f32_bf16 v32, v110, v42
    v_dot2c_f32_bf16 v32, v111, v43
    v_dot2c_f32_bf16 v32, v112, v44
    v_dot2c_f32_bf16 v32, v113, v45
    v_dot2c_f32_bf16 v32, v114, v46
    v_dot2c_f32_bf16 v32, v115, v47
    v_mov_b32 v33, 0
    v_dot2c_f32_bf16 v33, v116, v36
    v_dot2c_f32_bf16 v33, v117, v37
    v_dot2c_f32_bf16 v33, v118, v38
    v_dot2c_f32_bf16 v33, v119, v39
    v_dot2c_f32_bf16 v33, v120, v40
    v_dot2c_f32_bf16 v33, v121, v41
    v_dot2c_f32_bf16 v33, v122, v42
    v_dot2c_f32_bf16 v33, v123, v43
    v_dot2c_f32_bf16 v33, v124, v44
    v_dot2c_f32_bf16 v33, v125, v45
    v_dot2c_f32_bf16 v33, v126, v46
    v_dot2c_f32_bf16 v33, v127, v47
    s_waitcnt vmcnt(4)
    buffer_load_dwordx4 v[76:79], v1, s[32:35], s72 offen offset:256 nt
    v_mov_b32 v34, 0
    v_dot2c_f32_bf16 v34, v56, v36
    v_dot2c_f32_bf16 v34, v57, v37
    v_dot2c_f32_bf16 v34, v58, v38
    v_dot2c_f32_bf16 v34, v59, v39
    s_waitcnt vmcnt(4)
    ds_add_u32 v4, v3 offset:21952
    buffer_load_dwordx4 v[80:83], v1, s[36:39], 0 offen offset:0 nt
    v_dot2c_f32_bf16 v34, v60, v40
    v_dot2c_f32_bf16 v34, v61, v41
    v_dot2c_f32_bf16 v34, v62, v42
    v_dot2c_f32_bf16 v34, v63, v43
    s_waitcnt vmcnt(4)
    buffer_load_dwordx4 v[84:87], v1, s[36:39], 0 offen offset:128 nt
    v_dot2c_f32_bf16 v34, v64, v44
    v_dot2c_f32_bf16 v34, v65, v45
    v_dot2c_f32_bf16 v34, v66, v46
    v_dot2c_f32_bf16 v34, v67, v47
    s_waitcnt vmcnt(4)
    buffer_load_dwordx4 v[88:91], v1, s[36:39], 0 offen offset:256 nt
    v_mov_b32 v35, 0
    v_dot2c_f32_bf16 v35, v68, v36
    v_dot2c_f32_bf16 v35, v69, v37
    v_dot2c_f32_bf16 v35, v70, v38
    v_dot2c_f32_bf16 v35, v71, v39
    s_waitcnt vmcnt(4)
    ds_add_u32 v4, v3 offset:21952
    s_mov_b32 s72, 3072
    buffer_load_dwordx4 v[92:95], v1, s[36:39], s72 offen offset:0 nt
    v_dot2c_f32_bf16 v35, v72, v40
    v_dot2c_f32_bf16 v35, v73, v41
    v_dot2c_f32_bf16 v35, v74, v42
    v_dot2c_f32_bf16 v35, v75, v43
    s_waitcnt vmcnt(4)
    buffer_load_dwordx4 v[96:99], v1, s[36:39], s72 offen offset:128 nt
    v_dot2c_f32_bf16 v35, v76, v44
    v_dot2c_f32_bf16 v35, v77, v45
    v_dot2c_f32_bf16 v35, v78, v46
    v_dot2c_f32_bf16 v35, v79, v47
    s_waitcnt vmcnt(4)
    buffer_load_dwordx4 v[100:103], v1, s[36:39], s72 offen offset:256 nt
    s_nop 2
    v_add_f32_dpp v28, v28, v28 quad_perm:[1,0,3,2] row_mask:0xf bank_mask:0xf
    v_add_f32_dpp v29, v29, v29 quad_perm:[1,0,3,2] row_mask:0xf bank_mask:0xf
    v_add_f32_dpp v30, v30, v30 quad_perm:[1,0,3,2] row_mask:0xf bank_mask:0xf
    v_add_f32_dpp v31, v31, v31 quad_perm:[1,0,3,2] row_mask:0xf bank_mask:0xf
    v_add_f32_dpp v32, v32, v32 quad_perm:[1,0,3,2] row_mask:0xf bank_mask:0xf
    v_add_f32_dpp v33, v33, v33 quad_perm:[1,0,3,2] row_mask:0xf bank_mask:0xf
    v_add_f32_dpp v34, v34, v34 quad_perm:[1,0,3,2] row_mask:0xf bank_mask:0xf
    v_add_f32_dpp v35, v35, v35 quad_perm:[1,0,3,2] row_mask:0xf bank_mask:0xf
    v_add_f32_dpp v28, v28, v28 quad_perm:[2,3,0,1] row_mask:0xf bank_mask:0xf
    v_add_f32_dpp v29, v29, v29 quad_perm:[2,3,0,1] row_mask:0xf bank_mask:0xf
    v_add_f32_dpp v30, v30, v30 quad_perm:[2,3,0,1] row_mask:0xf bank_mask:0xf
    v_add_f32_dpp v31, v31, v31 quad_perm:[2,3,0,1] row_mask:0xf bank_mask:0xf
    v_add_f32_dpp v32, v32, v32 quad_perm:[2,3,0,1] row_mask:0xf bank_mask:0xf
    v_add_f32_dpp v33, v33, v33 quad_perm:[2,3,0,1] row_mask:0xf bank_mask:0xf
    v_add_f32_dpp v34, v34, v34 quad_perm:[2,3,0,1] row_mask:0xf bank_mask:0xf
    v_add_f32_dpp v35, v35, v35 quad_perm:[2,3,0,1] row_mask:0xf bank_mask:0xf
    v_add_f32_dpp v28, v28, v28 row_half_mirror row_mask:0xf bank_mask:0xf
    v_add_f32_dpp v29, v29, v29 row_half_mirror row_mask:0xf bank_mask:0xf
    v_add_f32_dpp v30, v30, v30 row_half_mirror row_mask:0xf bank_mask:0xf
    v_add_f32_dpp v31, v31, v31 row_half_mirror row_mask:0xf bank_mask:0xf
    v_add_f32_dpp v32, v32, v32 row_half_mirror row_mask:0xf bank_mask:0xf
    v_add_f32_dpp v33, v33, v33 row_half_mirror row_mask:0xf bank_mask:0xf
    v_add_f32_dpp v34, v34, v34 row_half_mirror row_mask:0xf bank_mask:0xf
    v_add_f32_dpp v35, v35, v35 row_half_mirror row_mask:0xf bank_mask:0xf
    s_waitcnt vmcnt(4)
    ds_add_u32 v4, v3 offset:21952
    s_mov_b32 s72, 6144
    buffer_load_dwordx4 v[104:107], v1, s[36:39], s72 offen offset:0 nt
    v_max3_f32 v49, v28, v29, v30
    v_max3_f32 v50, v31, v32, v33
    v_max3_f32 v49, v49, v34, v35
    v_max_f32 v49, v49, v50
    s_nop 1
    v_max_f32_dpp v49, v49, v49 row_ror:8 row_mask:0xf bank_mask:0xf
    s_nop 1
    v_max_f32_dpp v49, v49, v49 row_bcast:15 row_mask:0xa bank_mask:0xf
    s_nop 1
    v_max_f32_dpp v49, v49, v49 row_bcast:31 row_mask:0xc bank_mask:0xf
    v_mul_f32 v49, s73, v49
    v_mov_b32 v50, s73
    v_readlane_b32 s91, v49, 63
    s_nop 1
    s_mov_b32 s74, s91
    s_waitcnt vmcnt(4)
    buffer_load_dwordx4 v[108:111], v1, s[36:39], s72 offen offset:128 nt
    v_fma_f32 v28, v28, v50, -s91
    v_fma_f32 v29, v29, v50, -s91
    v_fma_f32 v30, v30, v50, -s91
    v_fma_f32 v31, v31, v50, -s91
    v_fma_f32 v32, v32, v50, -s91
    v_fma_f32 v33, v33, v50, -s91
    v_fma_f32 v34, v34, v50, -s91
    v_fma_f32 v35, v35, v50, -s91
    v_exp_f32 v28, v28
    v_exp_f32 v29, v29
    v_exp_f32 v30, v30
    v_exp_f32 v31, v31
    v_exp_f32 v32, v32
    v_exp_f32 v33, v33
    v_exp_f32 v34, v34
    v_exp_f32 v35, v35
    s_waitcnt vmcnt(4)
    buffer_load_dwordx4 v[112:115], v1, s[36:39], s72 offen offset:256 nt
    v_add_f32 v49, v28, v29
    v_add_f32 v50, v30, v31
    v_add_f32 v51, v32, v33
    v_add_f32 v52, v34, v35
    v_add_f32 v49, v49, v50
    v_add_f32 v51, v51, v52
    v_add_f32 v48, v49, v51
    v_cvt_pk_bf16_f32 v28, v28, v28
    v_cvt_pk_bf16_f32 v29, v29, v29
    v_cvt_pk_bf16_f32 v30, v30, v30
    v_cvt_pk_bf16_f32 v31, v31, v31
    v_cvt_pk_bf16_f32 v32, v32, v32
    v_cvt_pk_bf16_f32 v33, v33, v33
    v_cvt_pk_bf16_f32 v34, v34, v34
    v_cvt_pk_bf16_f32 v35, v35, v35
    s_waitcnt vmcnt(4)
    ds_add_u32 v4, v3 offset:21952
    s_mov_b32 s72, 9216
    buffer_load_dwordx4 v[116:119], v1, s[36:39], s72 offen offset:0 nt
    v_and_b32 v8, v12, v28
    v_and_b32 v9, v13, v28
    v_and_b32 v10, v14, v28
    v_and_b32 v11, v15, v28
    s_nop 1
    v_mfma_f32_16x16x32_bf16 v[16:19], v[80:83], v[8:11], 0
    v_mfma_f32_16x16x32_bf16 v[20:23], v[84:87], v[8:11], 0
    v_mfma_f32_16x16x32_bf16 v[24:27], v[88:91], v[8:11], 0
    v_and_b32 v8, v12, v29
    v_and_b32 v9, v13, v29
    v_and_b32 v10, v14, v29
    v_and_b32 v11, v15, v29
    s_nop 1
    s_waitcnt vmcnt(4)
    buffer_load_dwordx4 v[120:123], v1, s[36:39], s72 offen offset:128 nt
    v_mfma_f32_16x16x32_bf16 v[16:19], v[92:95], v[8:11], v[16:19]
    v_mfma_f32_16x16x32_bf16 v[20:23], v[96:99], v[8:11], v[20:23]
    v_mfma_f32_16x16x32_bf16 v[24:27], v[100:103], v[8:11], v[24:27]
    s_waitcnt vmcnt(4)
    buffer_load_dwordx4 v[124:127], v1, s[36:39], s72 offen offset:256 nt
    v_and_b32 v8, v12, v30
    v_and_b32 v9, v13, v30
    v_and_b32 v10, v14, v30
    v_and_b32 v11, v15, v30
    s_nop 1
    v_mfma_f32_16x16x32_bf16 v[16:19], v[104:107], v[8:11], v[16:19]
    s_waitcnt vmcnt(4)
    ds_add_u32 v4, v3 offset:21952
    s_mov_b32 s72, 12288
    buffer_load_dwordx4 v[56:59], v1, s[36:39], s72 offen offset:0 nt
    v_mfma_f32_16x16x32_bf16 v[20:23], v[108:111], v[8:11], v[20:23]
    s_waitcnt vmcnt(4)
    buffer_load_dwordx4 v[60:63], v1, s[36:39], s72 offen offset:128 nt
    v_mfma_f32_16x16x32_bf16 v[24:27], v[112:115], v[8:11], v[24:27]
    s_waitcnt vmcnt(4)
    buffer_load_dwordx4 v[64:67], v1, s[36:39], s72 offen offset:256 nt
    v_and_b32 v8, v12, v31
    v_and_b32 v9, v13, v31
    v_and_b32 v10, v14, v31
    v_and_b32 v11, v15, v31
    s_nop 1
    v_mfma_f32_16x16x32_bf16 v[16:19], v[116:119], v[8:11], v[16:19]
    s_waitcnt vmcnt(4)
    ds_add_u32 v4, v3 offset:21952
    s_mov_b32 s72, 15360
    buffer_load_dwordx4 v[68:71], v1, s[36:39], s72 offen offset:0 nt
    v_mfma_f32_16x16x32_bf16 v[20:23], v[120:123], v[8:11], v[20:23]
    s_waitcnt vmcnt(4)
    buffer_load_dwordx4 v[72:75], v1, s[36:39], s72 offen offset:128 nt
    v_mfma_f32_16x16x32_bf16 v[24:27], v[124:127], v[8:11], v[24:27]
    s_waitcnt vmcnt(4)
    buffer_load_dwordx4 v[76:79], v1, s[36:39], s72 offen offset:256 nt
    v_and_b32 v8, v12, v32
    v_and_b32 v9, v13, v32
    v_and_b32 v10, v14, v32
    v_and_b32 v11, v15, v32
    s_nop 1
    v_mfma_f32_16x16x32_bf16 v[16:19], v[56:59], v[8:11], v[16:19]
    s_waitcnt vmcnt(4)
    ds_add_u32 v4, v3 offset:21952
    s_mov_b32 s72, 18432
    buffer_load_dwordx4 v[80:83], v1, s[36:39], s72 offen offset:0 nt
    v_mfma_f32_16x16x32_bf16 v[20:23], v[60:63], v[8:11], v[20:23]
    s_waitcnt vmcnt(4)
    buffer_load_dwordx4 v[84:87], v1, s[36:39], s72 offen offset:128 nt
    v_mfma_f32_16x16x32_bf16 v[24:27], v[64:67], v[8:11], v[24:27]
    s_waitcnt vmcnt(4)
    buffer_load_dwordx4 v[88:91], v1, s[36:39], s72 offen offset:256 nt
    v_and_b32 v8, v12, v33
    v_and_b32 v9, v13, v33
    v_and_b32 v10, v14, v33
    v_and_b32 v11, v15, v33
    s_nop 1
    v_mfma_f32_16x16x32_bf16 v[16:19], v[68:71], v[8:11], v[16:19]
    s_waitcnt vmcnt(4)
    ds_add_u32 v4, v3 offset:21952
    s_mov_b32 s72, 21504
    buffer_load_dwordx4 v[92:95], v1, s[36:39], s72 offen offset:0 nt
    v_mfma_f32_16x16x32_bf16 v[20:23], v[72:75], v[8:11], v[20:23]
    s_waitcnt vmcnt(4)
    buffer_load_dwordx4 v[96:99], v1, s[36:39], s72 offen offset:128 nt
    v_mfma_f32_16x16x32_bf16 v[24:27], v[76:79], v[8:11], v[24:27]
    s_waitcnt vmcnt(4)
    buffer_load_dwordx4 v[100:103], v1, s[36:39], s72 offen offset:256 nt
    v_and_b32 v8, v12, v34
    v_and_b32 v9, v13, v34
    v_and_b32 v10, v14, v34
    v_and_b32 v11, v15, v34
    s_nop 1
    v_mfma_f32_16x16x32_bf16 v[16:19], v[80:83], v[8:11], v[16:19]
    s_waitcnt vmcnt(4)
    ds_add_u32 v4, v3 offset:21952
    s_mov_b32 s72, 24576
    buffer_load_dwordx4 v[104:107], v1, s[32:35], s72 offen offset:0 nt
    v_mfma_f32_16x16x32_bf16 v[20:23], v[84:87], v[8:11], v[20:23]
    s_waitcnt vmcnt(4)
    buffer_load_dwordx4 v[108:111], v1, s[32:35], s72 offen offset:128 nt
    v_mfma_f32_16x16x32_bf16 v[24:27], v[88:91], v[8:11], v[24:27]
    s_waitcnt vmcnt(4)
    buffer_load_dwordx4 v[112:115], v1, s[32:35], s72 offen offset:256 nt
    v_and_b32 v8, v12, v35
    v_and_b32 v9, v13, v35
    v_and_b32 v10, v14, v35
    v_and_b32 v11, v15, v35
    s_nop 1
    v_mfma_f32_16x16x32_bf16 v[16:19], v[92:95], v[8:11], v[16:19]
    s_waitcnt vmcnt(4)
    ds_add_u32 v4, v3 offset:21952
    s_mov_b32 s72, 27648
    buffer_load_dwordx4 v[116:119], v1, s[32:35], s72 offen offset:0 nt
    v_mfma_f32_16x16x32_bf16 v[20:23], v[96:99], v[8:11], v[20:23]
    s_waitcnt vmcnt(4)
    buffer_load_dwordx4 v[120:123], v1, s[32:35], s72 offen offset:128 nt
    v_mfma_f32_16x16x32_bf16 v[24:27], v[100:103], v[8:11], v[24:27]
    s_waitcnt vmcnt(4)
    buffer_load_dwordx4 v[124:127], v1, s[32:35], s72 offen offset:256 nt
    v_mov_b32 v28, 0
    v_dot2c_f32_bf16 v28, v104, v36
    v_dot2c_f32_bf16 v28, v105, v37
    v_dot2c_f32_bf16 v28, v106, v38
    v_dot2c_f32_bf16 v28, v107, v39
    s_cbranch_vccnz L_w54
    s_waitcnt vmcnt(4)
    s_cmp_eq_u32 s31, 0
    s_cbranch_scc1 L_w54
    s_waitcnt vmcnt(3)
L_w54:
    ds_add_u32 v4, v3 offset:21952
    s_mov_b32 s72, 30720
    buffer_load_dwordx4 v[56:59], v1, s[32:35], s72 offen offset:0 nt
    s_cbranch_vccnz L_w55
    s_waitcnt vmcnt(4)
    s_cmp_eq_u32 s31, 0
    s_cbranch_scc1 L_w55
    s_waitcnt vmcnt(3)
L_w55:
    s_waitcnt vmcnt(5)
    buffer_load_dwordx4 v[60:63], v1, s[32:35], s72 offen offset:128 nt
    v_dot2c_f32_bf16 v28, v108, v40
    v_dot2c_f32_bf16 v28, v109, v41
    v_dot2c_f32_bf16 v28, v110, v42
    v_dot2c_f32_bf16 v28, v111, v43
    s_cbranch_vccnz L_w56
    s_waitcnt vmcnt(4)
    s_cmp_eq_u32 s31, 0
    s_cbranch_scc1 L_w56
    s_waitcnt vmcnt(3)
L_w56:
    s_waitcnt vmcnt(5)
    buffer_load_dwordx4 v[64:67], v1, s[32:35], s72 offen offset:256 nt
    v_dot2c_f32_bf16 v28, v112, v44
    v_dot2c_f32_bf16 v28, v113, v45
    v_dot2c_f32_bf16 v28, v114, v46
    v_dot2c_f32_bf16 v28, v115, v47
    s_cbranch_vccnz L_w57
    s_waitcnt vmcnt(4)
    s_cmp_eq_u32 s31, 0
    s_cbranch_scc1 L_w57
    s_waitcnt vmcnt(3)
L_w57:
    s_waitcnt vmcnt(5)
    ds_add_u32 v4, v3 offset:21952
    s_mov_b32 s72, 33792
    buffer_load_dwordx4 v[68:71], v1, s[32:35], s72 offen offset:0 nt
    v_mov_b32 v29, 0
    v_dot2c_f32_bf16 v29, v116, v36
    v_dot2c_f32_bf16 v29, v117, v37
    v_dot2c_f32_bf16 v29, v118, v38
    v_dot2c_f32_bf16 v29, v119, v39
    s_cbranch_vccnz L_w58
    s_waitcnt vmcnt(4)
    s_cmp_eq_u32 s31, 0
    s_cbranch_scc1 L_w58
    s_waitcnt vmcnt(3)
L_w58:
    s_waitcnt vmcnt(5)
    buffer_load_dwordx4 v[72:75], v1, s[32:35], s72 offen offset:128 nt
    v_dot2c_f32_bf16 v29, v120, v40
    v_dot2c_f32_bf16 v29, v121, v41
    v_dot2c_f32_bf16 v29, v122, v42
    v_dot2c_f32_bf16 v29, v123, v43
    s_cbranch_vccnz L_w59
    s_waitcnt vmcnt(4)
    s_cmp_eq_u32 s31, 0
    s_cbranch_scc1 L_w59
    s_waitcnt vmcnt(3)
L_w59:
    s_waitcnt vmcnt(5)
    buffer_load_dwordx4 v[76:79], v1, s[32:35], s72 offen offset:256 nt
    v_dot2c_f32_bf16 v29, v124, v44
    v_dot2c_f32_bf16 v29, v125, v45
    v_dot2c_f32_bf16 v29, v126, v46
    v_dot2c_f32_bf16 v29, v127, v47
    s_cbranch_vccnz L_w60
    s_waitcnt vmcnt(4)
    s_cmp_eq_u32 s31, 0
    s_cbranch_scc1 L_w60
    s_waitcnt vmcnt(3)
L_w60:
    s_waitcnt vmcnt(5)
    ds_add_u32 v4, v3 offset:21952
    v_mov_b32 v53, 0
    ds_read_b32 v53, v53 offset:21936
    s_mov_b32 s72, 36864
    buffer_load_dwordx4 v[80:83], v1, s[32:35], s72 offen offset:0 nt
    v_mov_b32 v30, 0
    v_dot2c_f32_bf16 v30, v56, v36
    v_dot2c_f32_bf16 v30, v57, v37
    v_dot2c_f32_bf16 v30, v58, v38
    v_dot2c_f32_bf16 v30, v59, v39
    s_cbranch_vccnz L_w61
    s_waitcnt vmcnt(4)
    s_cmp_eq_u32 s31, 0
    s_cbranch_scc1 L_w61
    s_waitcnt vmcnt(3)
L_w61:
    s_waitcnt vmcnt(5)
    buffer_load_dwordx4 v[84:87], v1, s[32:35], s72 offen offset:128 nt
    v_dot2c_f32_bf16 v30, v60, v40
    v_dot2c_f32_bf16 v30, v61, v41
    v_dot2c_f32_bf16 v30, v62, v42
    v_dot2c_f32_bf16 v30, v63, v43
    s_cbranch_vccnz L_w62
    s_waitcnt vmcnt(4)
    s_cmp_eq_u32 s31, 0
    s_cbranch_scc1 L_w62
    s_waitcnt vmcnt(3)
L_w62:
    s_waitcnt vmcnt(5)
    s_waitcnt lgkmcnt(0)
    v_readfirstlane_b32 s30, v53
    s_and_b32 s31, s30, 1
    s_lshr_b32 s30, s30, 1
    s_cmp_lg_u32 s30, 0
    s_cselect_b64 vcc, -1, 0
    buffer_load_dwordx4 v[88:91], v1, s[32:35], s72 offen offset:256 nt
    v_dot2c_f32_bf16 v30, v64, v44
    v_dot2c_f32_bf16 v30, v65, v45
    v_dot2c_f32_bf16 v30, v66, v46
    v_dot2c_f32_bf16 v30, v67, v47
    s_cbranch_vccnz L_w63
    s_waitcnt vmcnt(4)
    s_cmp_eq_u32 s31, 0
    s_cbranch_scc1 L_w63
    s_waitcnt vmcnt(3)
L_w63:
    s_waitcnt vmcnt(5)
    ds_add_u32 v4, v3 offset:21952
    s_mov_b32 s72, 39936
    buffer_load_dwordx4 v[92:95], v1, s[32:35], s72 offen offset:0 nt
    v_mov_b32 v31, 0
    v_dot2c_f32_bf16 v31, v68, v36
    v_dot2c_f32_bf16 v31, v69, v37
    v_dot2c_f32_bf16 v31, v70, v38
    v_dot2c_f32_bf16 v31, v71, v39
    s_cbranch_vccnz L_w64
    s_waitcnt vmcnt(4)
    s_cmp_eq_u32 s31, 0
    s_cbranch_scc1 L_w64
    s_waitcnt vmcnt(3)
L_w64:
    s_waitcnt vmcnt(5)
    buffer_load_dwordx4 v[96:99], v1, s[32:35], s72 offen offset:128 nt
    v_dot2c_f32_bf16 v31, v72, v40
    v_dot2c_f32_bf16 v31, v73, v41
    v_dot2c_f32_bf16 v31, v74, v42
    v_dot2c_f32_bf16 v31, v75, v43
    s_cbranch_vccnz L_w65
    s_waitcnt vmcnt(4)
    s_cmp_eq_u32 s31, 0
    s_cbranch_scc1 L_w65
    s_waitcnt vmcnt(3)
L_w65:
    s_waitcnt vmcnt(5)
    buffer_load_dwordx4 v[100:103], v1, s[32:35], s72 offen offset:256 nt
    v_dot2c_f32_bf16 v31, v76, v44
    v_dot2c_f32_bf16 v31, v77, v45
    v_dot2c_f32_bf16 v31, v78, v46
    v_dot2c_f32_bf16 v31, v79, v47
    s_cbranch_vccnz L_w66
    s_waitcnt vmcnt(4)
    s_cmp_eq_u32 s31, 0
    s_cbranch_scc1 L_w66
    s_waitcnt vmcnt(3)
L_w66:
    s_waitcnt vmcnt(5)
    ds_add_u32 v4, v3 offset:21952
    v_mov_b32 v53, 0
    ds_read_b32 v53, v53 offset:21936
    s_mov_b32 s72, 43008
    buffer_load_dwordx4 v[104:107], v1, s[32:35], s72 offen offset:0 nt
    v_mov_b32 v32, 0
    v_dot2c_f32_bf16 v32, v80, v36
    v_dot2c_f32_bf16 v32, v81, v37
    v_dot2c_f32_bf16 v32, v82, v38
    v_dot2c_f32_bf16 v32, v83, v39
    s_cbranch_vccnz L_w67
    s_waitcnt vmcnt(4)
    s_cmp_eq_u32 s31, 0
    s_cbranch_scc1 L_w67
    s_waitcnt vmcnt(3)
L_w67:
    s_waitcnt vmcnt(5)
    buffer_load_dwordx4 v[108:111], v1, s[32:35], s72 offen offset:128 nt
    v_dot2c_f32_bf16 v32, v84, v40
    v_dot2c_f32_bf16 v32, v85, v41
    v_dot2c_f32_bf16 v32, v86, v42
    v_dot2c_f32_bf16 v32, v87, v43
    s_cbranch_vccnz L_w68
    s_waitcnt vmcnt(4)
    s_cmp_eq_u32 s31, 0
    s_cbranch_scc1 L_w68
    s_waitcnt vmcnt(3)
L_w68:
    s_waitcnt vmcnt(5)
    s_waitcnt lgkmcnt(0)
    v_readfirstlane_b32 s30, v53
    s_and_b32 s31, s30, 1
    s_lshr_b32 s30, s30, 1
    s_cmp_lg_u32 s30, 0
    s_cselect_b64 vcc, -1, 0
    buffer_load_dwordx4 v[112:115], v1, s[32:35], s72 offen offset:256 nt
    v_dot2c_f32_bf16 v32, v88, v44
    v_dot2c_f32_bf16 v32, v89, v45
    v_dot2c_f32_bf16 v32, v90, v46
    v_dot2c_f32_bf16 v32, v91, v47
    s_cbranch_vccnz L_w69
    s_waitcnt vmcnt(4)
    s_cmp_eq_u32 s31, 0
    s_cbranch_scc1 L_w69
    s_waitcnt vmcnt(3)
L_w69:
    s_waitcnt vmcnt(5)
    ds_add_u32 v4, v3 offset:21952
    s_mov_b32 s72, 46080
    buffer_load_dwordx4 v[116:119], v1, s[32:35], s72 offen offset:0 nt
    v_mov_b32 v33, 0
    v_dot2c_f32_bf16 v33, v92, v36
    v_dot2c_f32_bf16 v33, v93, v37
    v_dot2c_f32_bf16 v33, v94, v38
    v_dot2c_f32_bf16 v33, v95, v39
    s_cbranch_vccnz L_w70
    s_waitcnt vmcnt(4)
    s_cmp_eq_u32 s31, 0
    s_cbranch_scc1 L_w70
    s_waitcnt vmcnt(3)
L_w70:
    s_waitcnt vmcnt(5)
    buffer_load_dwordx4 v[120:123], v1, s[32:35], s72 offen offset:128 nt
    v_dot2c_f32_bf16 v33, v96, v40
    v_dot2c_f32_bf16 v33, v97, v41
    v_dot2c_f32_bf16 v33, v98, v42
    v_dot2c_f32_bf16 v33, v99, v43
    s_cbranch_vccnz L_w71
    s_waitcnt vmcnt(4)
    s_cmp_eq_u32 s31, 0
    s_cbranch_scc1 L_w71
    s_waitcnt vmcnt(3)
L_w71:
    s_waitcnt vmcnt(5)
    buffer_load_dwordx4 v[124:127], v1, s[32:35], s72 offen offset:256 nt
    v_dot2c_f32_bf16 v33, v100, v44
    v_dot2c_f32_bf16 v33, v101, v45
    v_dot2c_f32_bf16 v33, v102, v46
    v_dot2c_f32_bf16 v33, v103, v47
    s_cbranch_vccnz L_w72
    s_waitcnt vmcnt(4)
    s_cmp_eq_u32 s31, 0
    s_cbranch_scc1 L_w72
    s_waitcnt vmcnt(3)
L_w72:
    s_waitcnt vmcnt(5)
    ds_add_u32 v4, v3 offset:21952
    v_mov_b32 v53, 0
    ds_read_b32 v53, v53 offset:21936
    s_mov_b32 s72, 24576
    buffer_load_dwordx4 v[56:59], v1, s[36:39], s72 offen offset:0 nt
    v_mov_b32 v34, 0
    v_dot2c_f32_bf16 v34, v104, v36
    v_dot2c_f32_bf16 v34, v105, v37
    v_dot2c_f32_bf16 v34, v106, v38
    v_dot2c_f32_bf16 v34, v107, v39
    s_cbranch_vccnz L_w73
    s_waitcnt vmcnt(4)
    s_cmp_eq_u32 s31, 0
    s_cbranch_scc1 L_w73
    s_waitcnt vmcnt(3)
L_w73:
    s_waitcnt vmcnt(5)
    buffer_load_dwordx4 v[60:63], v1, s[36:39], s72 offen offset:128 nt
    v_dot2c_f32_bf16 v34, v108, v40
    v_dot2c_f32_bf16 v34, v109, v41
    v_dot2c_f32_bf16 v34, v110, v42
    v_dot2c_f32_bf16 v34, v111, v43
    s_cbranch_vccnz L_w74
    s_waitcnt vmcnt(4)
    s_cmp_eq_u32 s31, 0
    s_cbranch_scc1 L_w74
    s_waitcnt vmcnt(3)
L_w74:
    s_waitcnt vmcnt(5)
    s_waitcnt lgkmcnt(0)
    v_readfirstlane_b32 s30, v53
    s_and_b32 s31, s30, 1
    s_lshr_b32 s30, s30, 1
    s_cmp_lg_u32 s30, 0
    s_cselect_b64 vcc, -1, 0
    buffer_load_dwordx4 v[64:67], v1, s[36:39], s72 offen offset:256 nt
    v_dot2c_f32_bf16 v34, v112, v44
    v_dot2c_f32_bf16 v34, v113, v45
    v_dot2c_f32_bf16 v34, v114, v46
    v_dot2c_f32_bf16 v34, v115, v47
    s_cbranch_vccnz L_w75
    s_waitcnt vmcnt(4)
    s_cmp_eq_u32 s31, 0
    s_cbranch_scc1 L_w75
    s_waitcnt vmcnt(3)
L_w75:
    s_waitcnt vmcnt(5)
    ds_add_u32 v4, v3 offset:21952
    s_mov_b32 s72, 27648
    buffer_load_dwordx4 v[68:71], v1, s[36:39], s72 offen offset:0 nt
    v_mov_b32 v35, 0
    v_dot2c_f32_bf16 v35, v116, v36
    v_dot2c_f32_bf16 v35, v117, v37
    v_dot2c_f32_bf16 v35, v118, v38
    v_dot2c_f32_bf16 v35, v119, v39
    s_cbranch_vccnz L_w76
    s_waitcnt vmcnt(4)
    s_cmp_eq_u32 s31, 0
    s_cbranch_scc1 L_w76
    s_waitcnt vmcnt(3)
L_w76:
    s_waitcnt vmcnt(5)
    buffer_load_dwordx4 v[72:75], v1, s[36:39], s72 offen offset:128 nt
    v_dot2c_f32_bf16 v35, v120, v40
    v_dot2c_f32_bf16 v35, v121, v41
    v_dot2c_f32_bf16 v35, v122, v42
    v_dot2c_f32_bf16 v35, v123, v43
    s_cbranch_vccnz L_w77
    s_waitcnt vmcnt(4)
    s_cmp_eq_u32 s31, 0
    s_cbranch_scc1 L_w77
    s_waitcnt vmcnt(3)
L_w77:
    s_waitcnt vmcnt(5)
    buffer_load_dwordx4 v[76:79], v1, s[36:39], s72 offen offset:256 nt
    v_dot2c_f32_bf16 v35, v124, v44
    v_dot2c_f32_bf16 v35, v125, v45
    v_dot2c_f32_bf16 v35, v126, v46
    v_dot2c_f32_bf16 v35, v127, v47
    s_cbranch_vccnz L_w78
    s_waitcnt vmcnt(4)
    s_cmp_eq_u32 s31, 0
    s_cbranch_scc1 L_w78
    s_waitcnt vmcnt(3)
L_w78:
    s_waitcnt vmcnt(5)
    ds_add_u32 v4, v3 offset:21952
    v_mov_b32 v53, 0
    ds_read_b32 v53, v53 offset:21936
    s_mov_b32 s72, 30720
    buffer_load_dwordx4 v[80:83], v1, s[36:39], s72 offen offset:0 nt
    s_nop 2
    v_add_f32_dpp v28, v28, v28 quad_perm:[1,0,3,2] row_mask:0xf bank_mask:0xf
    v_add_f32_dpp v29, v29, v29 quad_perm:[1,0,3,2] row_mask:0xf bank_mask:0xf
    v_add_f32_dpp v30, v30, v30 quad_perm:[1,0,3,2] row_mask:0xf bank_mask:0xf
    v_add_f32_dpp v31, v31, v31 quad_perm:[1,0,3,2] row_mask:0xf bank_mask:0xf
    v_add_f32_dpp v32, v32, v32 quad_perm:[1,0,3,2] row_mask:0xf bank_mask:0xf
    v_add_f32_dpp v33, v33, v33 quad_perm:[1,0,3,2] row_mask:0xf bank_mask:0xf
    v_add_f32_dpp v34, v34, v34 quad_perm:[1,0,3,2] row_mask:0xf bank_mask:0xf
    v_add_f32_dpp v35, v35, v35 quad_perm:[1,0,3,2] row_mask:0xf bank_mask:0xf
    v_add_f32_dpp v28, v28, v28 quad_perm:[2,3,0,1] row_mask:0xf bank_mask:0xf
    v_add_f32_dpp v29, v29, v29 quad_perm:[2,3,0,1] row_mask:0xf bank_mask:0xf
    v_add_f32_dpp v30, v30, v30 quad_perm:[2,3,0,1] row_mask:0xf bank_mask:0xf
    v_add_f32_dpp v31, v31, v31 quad_perm:[2,3,0,1] row_mask:0xf bank_mask:0xf
    v_add_f32_dpp v32, v32, v32 quad_perm:[2,3,0,1] row_mask:0xf bank_mask:0xf
    v_add_f32_dpp v33, v33, v33 quad_perm:[2,3,0,1] row_mask:0xf bank_mask:0xf
    v_add_f32_dpp v34, v34, v34 quad_perm:[2,3,0,1] row_mask:0xf bank_mask:0xf
    v_add_f32_dpp v35, v35, v35 quad_perm:[2,3,0,1] row_mask:0xf bank_mask:0xf
    v_add_f32_dpp v28, v28, v28 row_half_mirror row_mask:0xf bank_mask:0xf
    v_add_f32_dpp v29, v29, v29 row_half_mirror row_mask:0xf bank_mask:0xf
    v_add_f32_dpp v30, v30, v30 row_half_mirror row_mask:0xf bank_mask:0xf
    v_add_f32_dpp v31, v31, v31 row_half_mirror row_mask:0xf bank_mask:0xf
    v_add_f32_dpp v32, v32, v32 row_half_mirror row_mask:0xf bank_mask:0xf
    v_add_f32_dpp v33, v33, v33 row_half_mirror row_mask:0xf bank_mask:0xf
    v_add_f32_dpp v34, v34, v34 row_half_mirror row_mask:0xf bank_mask:0xf
    v_add_f32_dpp v35, v35, v35 row_half_mirror row_mask:0xf bank_mask:0xf
    s_cbranch_vccnz L_w79
    s_waitcnt vmcnt(4)
    s_cmp_eq_u32 s31, 0
    s_cbranch_scc1 L_w79
    s_waitcnt vmcnt(3)
L_w79:
    s_waitcnt vmcnt(5)
    buffer_load_dwordx4 v[84:87], v1, s[36:39], s72 offen offset:128 nt
    v_max3_f32 v49, v28, v29, v30
    v_max3_f32 v50, v31, v32, v33
    v_max3_f32 v49, v49, v34, v35
    v_max_f32 v49, v49, v50
    s_nop 1
    v_max_f32_dpp v49, v49, v49 row_ror:8 row_mask:0xf bank_mask:0xf
    s_nop 1
    v_max_f32_dpp v49, v49, v49 row_bcast:15 row_mask:0xa bank_mask:0xf
    s_nop 1
    v_max_f32_dpp v49, v49, v49 row_bcast:31 row_mask:0xc bank_mask:0xf
    v_mul_f32 v49, s73, v49
    v_max_f32 v49, s74, v49
    v_mov_b32 v50, s73
    v_readlane_b32 s91, v49, 63
    v_mov_b32 v54, s74
    s_nop 0
    v_subrev_f32 v54, s91, v54
    v_exp_f32 v54, v54
    s_mov_b32 s74, s91
    s_cbranch_vccnz L_w80
    s_waitcnt vmcnt(4)
    s_cmp_eq_u32 s31, 0
    s_cbranch_scc1 L_w80
    s_waitcnt vmcnt(3)
L_w80:
    s_waitcnt vmcnt(5)
    s_waitcnt lgkmcnt(0)
    v_readfirstlane_b32 s30, v53
    s_and_b32 s31, s30, 1
    s_lshr_b32 s30, s30, 1
    s_cmp_lg_u32 s30, 0
    s_cselect_b64 vcc, -1, 0
    buffer_load_dwordx4 v[88:91], v1, s[36:39], s72 offen offset:256 nt
    v_fma_f32 v28, v28, v50, -s91
    v_fma_f32 v29, v29, v50, -s91
    v_fma_f32 v30, v30, v50, -s91
    v_fma_f32 v31, v31, v50, -s91
    v_fma_f32 v32, v32, v50, -s91
    v_fma_f32 v33, v33, v50, -s91
    v_fma_f32 v34, v34, v50, -s91
    v_fma_f32 v35, v35, v50, -s91
    v_exp_f32 v28, v28
    v_exp_f32 v29, v29
    v_exp_f32 v30, v30
    v_exp_f32 v31, v31
    v_exp_f32 v32, v32
    v_exp_f32 v33, v33
    v_exp_f32 v34, v34
    v_exp_f32 v35, v35
    s_cbranch_vccnz L_w81
    s_waitcnt vmcnt(4)
    s_cmp_eq_u32 s31, 0
    s_cbranch_scc1 L_w81
    s_waitcnt vmcnt(3)
L_w81:
    s_waitcnt vmcnt(5)
    ds_add_u32 v4, v3 offset:21952
    s_mov_b32 s72, 33792
    buffer_load_dwordx4 v[92:95], v1, s[36:39], s72 offen offset:0 nt
    v_add_f32 v49, v28, v29
    v_add_f32 v50, v30, v31
    v_add_f32 v51, v32, v33
    v_add_f32 v52, v34, v35
    v_add_f32 v49, v49, v50
    v_add_f32 v51, v51, v52
    v_add_f32 v49, v49, v51
    v_fma_f32 v48, v48, v54, v49
    v_mul_f32 v16, v16, v54
    v_mul_f32 v17, v17, v54
    v_mul_f32 v18, v18, v54
    v_mul_f32 v19, v19, v54
    v_mul_f32 v20, v20, v54
    v_mul_f32 v21, v21, v54
    v_mul_f32 v22, v22, v54
    v_mul_f32 v23, v23, v54
    v_mul_f32 v24, v24, v54
    v_mul_f32 v25, v25, v54
    v_mul_f32 v26, v26, v54
    v_mul_f32 v27, v27, v54
    v_cvt_pk_bf16_f32 v28, v28, v28
    v_cvt_pk_bf16_f32 v29, v29, v29
    v_cvt_pk_bf16_f32 v30, v30, v30
    v_cvt_pk_bf16_f32 v31, v31, v31
    v_cvt_pk_bf16_f32 v32, v32, v32
    v_cvt_pk_bf16_f32 v33, v33, v33
    v_cvt_pk_bf16_f32 v34, v34, v34
    v_cvt_pk_bf16_f32 v35, v35, v35
    s_cbranch_vccnz L_w82
    s_waitcnt vmcnt(4)
    s_cmp_eq_u32 s31, 0
    s_cbranch_scc1 L_w82
    s_waitcnt vmcnt(3)
L_w82:
    s_waitcnt vmcnt(5)
    buffer_load_dwordx4 v[96:99], v1, s[36:39], s72 offen offset:128 nt
    v_and_b32 v8, v12, v28
    v_and_b32 v9, v13, v28
    v_and_b32 v10, v14, v28
    v_and_b32 v11, v15, v28
    s_nop 1
    v_mfma_f32_16x16x32_bf16 v[16:19], v[56:59], v[8:11], v[16:19]
    v_mfma_f32_16x16x32_bf16 v[20:23], v[60:63], v[8:11], v[20:23]
    v_mfma_f32_16x16x32_bf16 v[24:27], v[64:67], v[8:11], v[24:27]
    v_and_b32 v8, v12, v29
    v_and_b32 v9, v13, v29
    v_and_b32 v10, v14, v29
    v_and_b32 v11, v15, v29
    s_nop 1
    s_cbranch_vccnz L_w83
    s_waitcnt vmcnt(4)
    s_cmp_eq_u32 s31, 0
    s_cbranch_scc1 L_w83
    s_waitcnt vmcnt(3)
L_w83:
    s_waitcnt vmcnt(5)
    buffer_load_dwordx4 v[100:103], v1, s[36:39], s72 offen offset:256 nt
    v_mfma_f32_16x16x32_bf16 v[16:19], v[68:71], v[8:11], v[16:19]
    v_mfma_f32_16x16x32_bf16 v[20:23], v[72:75], v[8:11], v[20:23]
    v_mfma_f32_16x16x32_bf16 v[24:27], v[76:79], v[8:11], v[24:27]
    s_cbranch_vccnz L_w84
    s_waitcnt vmcnt(4)
    s_cmp_eq_u32 s31, 0
    s_cbranch_scc1 L_w84
    s_waitcnt vmcnt(3)
L_w84:
    s_waitcnt vmcnt(5)
    ds_add_u32 v4, v3 offset:21952
    v_mov_b32 v53, 0
    ds_read_b32 v53, v53 offset:21936
    s_mov_b32 s72, 36864
    buffer_load_dwordx4 v[104:107], v1, s[36:39], s72 offen offset:0 nt
    v_and_b32 v8, v12, v30
    v_and_b32 v9, v13, v30
    v_and_b32 v10, v14, v30
    v_and_b32 v11, v15, v30
    s_nop 1
    v_mfma_f32_16x16x32_bf16 v[16:19], v[80:83], v[8:11], v[16:19]
    s_cbranch_vccnz L_w85
    s_waitcnt vmcnt(4)
    s_cmp_eq_u32 s31, 0
    s_cbranch_scc1 L_w85
    s_waitcnt vmcnt(3)
L_w85:
    s_waitcnt vmcnt(5)
    buffer_load_dwordx4 v[108:111], v1, s[36:39], s72 offen offset:128 nt
    v_mfma_f32_16x16x32_bf16 v[20:23], v[84:87], v[8:11], v[20:23]
    s_cbranch_vccnz L_w86
    s_waitcnt vmcnt(4)
    s_cmp_eq_u32 s31, 0
    s_cbranch_scc1 L_w86
    s_waitcnt vmcnt(3)
L_w86:
    s_waitcnt vmcnt(5)
    s_waitcnt lgkmcnt(0)
    v_readfirstlane_b32 s30, v53
    s_and_b32 s31, s30, 1
    s_lshr_b32 s30, s30, 1
    s_cmp_lg_u32 s30, 0
    s_cselect_b64 vcc, -1, 0
    buffer_load_dwordx4 v[112:115], v1, s[36:39], s72 offen offset:256 nt
    v_mfma_f32_16x16x32_bf16 v[24:27], v[88:91], v[8:11], v[24:27]
    s_cbranch_vccnz L_w87
    s_waitcnt vmcnt(4)
    s_cmp_eq_u32 s31, 0
    s_cbranch_scc1 L_w87
    s_waitcnt vmcnt(3)
L_w87:
    s_waitcnt vmcnt(5)
    ds_add_u32 v4, v3 offset:21952
    s_mov_b32 s72, 39936
    buffer_load_dwordx4 v[116:119], v1, s[36:39], s72 offen offset:0 nt
    v_and_b32 v8, v12, v31
    v_and_b32 v9, v13, v31
    v_and_b32 v10, v14, v31
    v_and_b32 v11, v15, v31
    s_nop 1
    v_mfma_f32_16x16x32_bf16 v[16:19], v[92:95], v[8:11], v[16:19]
    s_cbranch_vccnz L_w88
    s_waitcnt vmcnt(4)
    s_cmp_eq_u32 s31, 0
    s_cbranch_scc1 L_w88
    s_waitcnt vmcnt(3)
L_w88:
    s_waitcnt vmcnt(5)
    buffer_load_dwordx4 v[120:123], v1, s[36:39], s72 offen offset:128 nt
    v_mfma_f32_16x16x32_bf16 v[20:23], v[96:99], v[8:11], v[20:23]
    s_cbranch_vccnz L_w89
    s_waitcnt vmcnt(4)
    s_cmp_eq_u32 s31, 0
    s_cbranch_scc1 L_w89
    s_waitcnt vmcnt(3)
L_w89:
    s_waitcnt vmcnt(5)
    buffer_load_dwordx4 v[124:127], v1, s[36:39], s72 offen offset:256 nt
    v_mfma_f32_16x16x32_bf16 v[24:27], v[100:103], v[8:11], v[24:27]
    s_cbranch_vccnz L_w90
    s_waitcnt vmcnt(4)
    s_cmp_eq_u32 s31, 0
    s_cbranch_scc1 L_w90
    s_waitcnt vmcnt(3)
L_w90:
    s_waitcnt vmcnt(5)
    ds_add_u32 v4, v3 offset:21952
    v_mov_b32 v53, 0
    ds_read_b32 v53, v53 offset:21936
    s_mov_b32 s72, 43008
    buffer_load_dwordx4 v[56:59], v1, s[36:39], s72 offen offset:0 nt
    v_and_b32 v8, v12, v32
    v_and_b32 v9, v13, v32
    v_and_b32 v10, v14, v32
    v_and_b32 v11, v15, v32
    s_nop 1
    v_mfma_f32_16x16x32_bf16 v[16:19], v[104:107], v[8:11], v[16:19]
    s_cbranch_vccnz L_w91
    s_waitcnt vmcnt(4)
    s_cmp_eq_u32 s31, 0
    s_cbranch_scc1 L_w91
    s_waitcnt vmcnt(3)
L_w91:
    s_waitcnt vmcnt(5)
    buffer_load_dwordx4 v[60:63], v1, s[36:39], s72 offen offset:128 nt
    v_mfma_f32_16x16x32_bf16 v[20:23], v[108:111], v[8:11], v[20:23]
    s_cbranch_vccnz L_w92
    s_waitcnt vmcnt(4)
    s_cmp_eq_u32 s31, 0
    s_cbranch_scc1 L_w92
    s_waitcnt vmcnt(3)
L_w92:
    s_waitcnt vmcnt(5)
    s_waitcnt lgkmcnt(0)
    v_readfirstlane_b32 s30, v53
    s_and_b32 s31, s30, 1
    s_lshr_b32 s30, s30, 1
    s_cmp_lg_u32 s30, 0
    s_cselect_b64 vcc, -1, 0
    buffer_load_dwordx4 v[64:67], v1, s[36:39], s72 offen offset:256 nt
    v_mfma_f32_16x16x32_bf16 v[24:27], v[112:115], v[8:11], v[24:27]
    s_cbranch_vccnz L_w93
    s_waitcnt vmcnt(4)
    s_cmp_eq_u32 s31, 0
    s_cbranch_scc1 L_w93
    s_waitcnt vmcnt(3)
L_w93:
    s_waitcnt vmcnt(5)
    ds_add_u32 v4, v3 offset:21952
    s_mov_b32 s72, 46080
    buffer_load_dwordx4 v[68:71], v1, s[36:39], s72 offen offset:0 nt
    v_and_b32 v8, v12, v33
    v_and_b32 v9, v13, v33
    v_and_b32 v10, v14, v33
    v_and_b32 v11, v15, v33
    s_nop 1
    v_mfma_f32_16x16x32_bf16 v[16:19], v[116:119], v[8:11], v[16:19]
    s_cbranch_vccnz L_w94
    s_waitcnt vmcnt(4)
    s_cmp_eq_u32 s31, 0
    s_cbranch_scc1 L_w94
    s_waitcnt vmcnt(3)
L_w94:
    s_waitcnt vmcnt(5)
    buffer_load_dwordx4 v[72:75], v1, s[36:39], s72 offen offset:128 nt
    v_mfma_f32_16x16x32_bf16 v[20:23], v[120:123], v[8:11], v[20:23]
    s_cbranch_vccnz L_w95
    s_waitcnt vmcnt(4)
    s_cmp_eq_u32 s31, 0
    s_cbranch_scc1 L_w95
    s_waitcnt vmcnt(3)
L_w95:
    s_waitcnt vmcnt(5)
    buffer_load_dwordx4 v[76:79], v1, s[36:39], s72 offen offset:256 nt
    v_mfma_f32_16x16x32_bf16 v[24:27], v[124:127], v[8:11], v[24:27]
    s_cbranch_vccnz L_w96
    s_waitcnt vmcnt(4)
    s_cmp_eq_u32 s31, 0
    s_cbranch_scc1 L_w96
    s_waitcnt vmcnt(3)
L_w96:
    s_waitcnt vmcnt(5)
    ds_add_u32 v4, v3 offset:21952
    v_mov_b32 v53, 0
    ds_read_b32 v53, v53 offset:21936
    s_mov_b32 s72, 49152
    buffer_load_dwordx4 v[80:83], v1, s[32:35], s72 offen offset:0 nt
    v_and_b32 v8, v12, v34
    v_and_b32 v9, v13, v34
    v_and_b32 v10, v14, v34
    v_and_b32 v11, v15, v34
    s_nop 1
    v_mfma_f32_16x16x32_bf16 v[16:19], v[56:59], v[8:11], v[16:19]
    s_cbranch_vccnz L_w97
    s_waitcnt vmcnt(4)
    s_cmp_eq_u32 s31, 0
    s_cbranch_scc1 L_w97
    s_waitcnt vmcnt(3)
L_w97:
    s_waitcnt vmcnt(5)
    buffer_load_dwordx4 v[84:87], v1, s[32:35], s72 offen offset:128 nt
    v_mfma_f32_16x16x32_bf16 v[20:23], v[60:63], v[8:11], v[20:23]
    s_cbranch_vccnz L_w98
    s_waitcnt vmcnt(4)
    s_cmp_eq_u32 s31, 0
    s_cbranch_scc1 L_w98
    s_waitcnt vmcnt(3)
L_w98:
    s_waitcnt vmcnt(5)
    s_waitcnt lgkmcnt(0)
    v_readfirstlane_b32 s30, v53
    s_and_b32 s31, s30, 1
    s_lshr_b32 s30, s30, 1
    s_cmp_lg_u32 s30, 0
    s_cselect_b64 vcc, -1, 0
    buffer_load_dwordx4 v[88:91], v1, s[32:35], s72 offen offset:256 nt
    v_mfma_f32_16x16x32_bf16 v[24:27], v[64:67], v[8:11], v[24:27]
    s_cbranch_vccnz L_w99
    s_waitcnt vmcnt(4)
    s_cmp_eq_u32 s31, 0
    s_cbranch_scc1 L_w99
    s_waitcnt vmcnt(3)
L_w99:
    s_waitcnt vmcnt(5)
    ds_add_u32 v4, v3 offset:21952
    s_mov_b32 s72, 52224
    buffer_load_dwordx4 v[92:95], v1, s[32:35], s72 offen offset:0 nt
    v_and_b32 v8, v12, v35
    v_and_b32 v9, v13, v35
    v_and_b32 v10, v14, v35
    v_and_b32 v11, v15, v35
    s_nop 1
    v_mfma_f32_16x16x32_bf16 v[16:19], v[68:71], v[8:11], v[16:19]
    s_cbranch_vccnz L_w100
    s_waitcnt vmcnt(4)
    s_cmp_eq_u32 s31, 0
    s_cbranch_scc1 L_w100
    s_waitcnt vmcnt(3)
L_w100:
    s_waitcnt vmcnt(5)
    buffer_load_dwordx4 v[96:99], v1, s[32:35], s72 offen offset:128 nt
    v_mfma_f32_16x16x32_bf16 v[20:23], v[72:75], v[8:11], v[20:23]
    s_cbranch_vccnz L_w101
    s_waitcnt vmcnt(4)
    s_cmp_eq_u32 s31, 0
    s_cbranch_scc1 L_w101
    s_waitcnt vmcnt(3)
L_w101:
    s_waitcnt vmcnt(5)
    buffer_load_dwordx4 v[100:103], v1, s[32:35], s72 offen offset:256 nt
    v_mfma_f32_16x16x32_bf16 v[24:27], v[76:79], v[8:11], v[24:27]
    s_cbranch_vccnz L_w102
    s_waitcnt vmcnt(4)
    s_cmp_eq_u32 s31, 0
    s_cbranch_scc1 L_w102
    s_waitcnt vmcnt(3)
L_w102:
    s_waitcnt vmcnt(5)
    ds_add_u32 v4, v3 offset:21952
    v_mov_b32 v53, 0
    ds_read_b32 v53, v53 offset:21936
    s_mov_b32 s72, 55296
    buffer_load_dwordx4 v[104:107], v1, s[32:35], s72 offen offset:0 nt
    v_mov_b32 v28, 0
    v_dot2c_f32_bf16 v28, v80, v36
    v_dot2c_f32_bf16 v28, v81, v37
    v_dot2c_f32_bf16 v28, v82, v38
    v_dot2c_f32_bf16 v28, v83, v39
    s_cbranch_vccnz L_w103
    s_waitcnt vmcnt(4)
    s_cmp_eq_u32 s31, 0
    s_cbranch_scc1 L_w103
    s_waitcnt vmcnt(3)
L_w103:
    s_waitcnt vmcnt(5)
    buffer_load_dwordx4 v[108:111], v1, s[32:35], s72 offen offset:128 nt
    v_dot2c_f32_bf16 v28, v84, v40
    v_dot2c_f32_bf16 v28, v85, v41
    v_dot2c_f32_bf16 v28, v86, v42
    v_dot2c_f32_bf16 v28, v87, v43
    s_cbranch_vccnz L_w104
    s_waitcnt vmcnt(4)
    s_cmp_eq_u32 s31, 0
    s_cbranch_scc1 L_w104
    s_waitcnt vmcnt(3)
L_w104:
    s_waitcnt vmcnt(5)
    s_waitcnt lgkmcnt(0)
    v_readfirstlane_b32 s30, v53
    s_and_b32 s31, s30, 1
    s_lshr_b32 s30, s30, 1
    s_cmp_lg_u32 s30, 0
    s_cselect_b64 vcc, -1, 0
    buffer_load_dwordx4 v[112:115], v1, s[32:35], s72 offen offset:256 nt
    v_dot2c_f32_bf16 v28, v88, v44
    v_dot2c_f32_bf16 v28, v89, v45
    v_dot2c_f32_bf16 v28, v90, v46
    v_dot2c_f32_bf16 v28, v91, v47
    s_cbranch_vccnz L_w105
    s_waitcnt vmcnt(4)
    s_cmp_eq_u32 s31, 0
    s_cbranch_scc1 L_w105
    s_waitcnt vmcnt(3)
L_w105:
    s_waitcnt vmcnt(5)
    ds_add_u32 v4, v3 offset:21952
    s_mov_b32 s72, 58368
    buffer_load_dwordx4 v[116:119], v1, s[32:35], s72 offen offset:0 nt
    v_mov_b32 v29, 0
    v_dot2c_f32_bf16 v29, v92, v36
    v_dot2c_f32_bf16 v29, v93, v37
    v_dot2c_f32_bf16 v29, v94, v38
    v_dot2c_f32_bf16 v29, v95, v39
    s_cbranch_vccnz L_w106
    s_waitcnt vmcnt(4)
    s_cmp_eq_u32 s31, 0
    s_cbranch_scc1 L_w106
    s_waitcnt vmcnt(3)
L_w106:
    s_waitcnt vmcnt(5)
    buffer_load_dwordx4 v[120:123], v1, s[32:35], s72 offen offset:128 nt
    v_dot2c_f32_bf16 v29, v96, v40
    v_dot2c_f32_bf16 v29, v97, v41
    v_dot2c_f32_bf16 v29, v98, v42
    v_dot2c_f32_bf16 v29, v99, v43
    s_cbranch_vccnz L_w107
    s_waitcnt vmcnt(4)
    s_cmp_eq_u32 s31, 0
    s_cbranch_scc1 L_w107
    s_waitcnt vmcnt(3)
L_w107:
    s_waitcnt vmcnt(5)
    buffer_load_dwordx4 v[124:127], v1, s[32:35], s72 offen offset:256 nt
    v_dot2c_f32_bf16 v29, v100, v44
    v_dot2c_f32_bf16 v29, v101, v45
    v_dot2c_f32_bf16 v29, v102, v46
    v_dot2c_f32_bf16 v29, v103, v47
    s_cbranch_vccnz L_w108
    s_waitcnt vmcnt(4)
    s_cmp_eq_u32 s31, 0
    s_cbranch_scc1 L_w108
    s_waitcnt vmcnt(3)
L_w108:
    s_waitcnt vmcnt(5)
    ds_add_u32 v4, v3 offset:21952
    v_mov_b32 v53, 0
    ds_read_b32 v53, v53 offset:21936
    s_mov_b32 s72, 61440
    buffer_load_dwordx4 v[56:59], v1, s[32:35], s72 offen offset:0 nt
    v_mov_b32 v30, 0
    v_dot2c_f32_bf16 v30, v104, v36
    v_dot2c_f32_bf16 v30, v105, v37
    v_dot2c_f32_bf16 v30, v106, v38
    v_dot2c_f32_bf16 v30, v107, v39
    s_cbranch_vccnz L_w109
    s_waitcnt vmcnt(4)
    s_cmp_eq_u32 s31, 0
    s_cbranch_scc1 L_w109
    s_waitcnt vmcnt(3)
L_w109:
    s_waitcnt vmcnt(5)
    buffer_load_dwordx4 v[60:63], v1, s[32:35], s72 offen offset:128 nt
    v_dot2c_f32_bf16 v30, v108, v40
    v_dot2c_f32_bf16 v30, v109, v41
    v_dot2c_f32_bf16 v30, v110, v42
    v_dot2c_f32_bf16 v30, v111, v43
    s_cbranch_vccnz L_w110
    s_waitcnt vmcnt(4)
    s_cmp_eq_u32 s31, 0
    s_cbranch_scc1 L_w110
    s_waitcnt vmcnt(3)
L_w110:
    s_waitcnt vmcnt(5)
    s_waitcnt lgkmcnt(0)
    v_readfirstlane_b32 s30, v53
    s_and_b32 s31, s30, 1
    s_lshr_b32 s30, s30, 1
    s_cmp_lg_u32 s30, 0
    s_cselect_b64 vcc, -1, 0
    buffer_load_dwordx4 v[64:67], v1, s[32:35], s72 offen offset:256 nt
    v_dot2c_f32_bf16 v30, v112, v44
    v_dot2c_f32_bf16 v30, v113, v45
    v_dot2c_f32_bf16 v30, v114, v46
    v_dot2c_f32_bf16 v30, v115, v47
    s_cbranch_vccnz L_w111
    s_waitcnt vmcnt(4)
    s_cmp_eq_u32 s31, 0
    s_cbranch_scc1 L_w111
    s_waitcnt vmcnt(3)
L_w111:
    s_waitcnt vmcnt(5)
    ds_add_u32 v4, v3 offset:21952
    s_mov_b32 s72, 64512
    buffer_load_dwordx4 v[68:71], v1, s[32:35], s72 offen offset:0 nt
    v_mov_b32 v31, 0
    v_dot2c_f32_bf16 v31, v116, v36
    v_dot2c_f32_bf16 v31, v117, v37
    v_dot2c_f32_bf16 v31, v118, v38
    v_dot2c_f32_bf16 v31, v119, v39
    s_cbranch_vccnz L_w112
    s_waitcnt vmcnt(4)
    s_cmp_eq_u32 s31, 0
    s_cbranch_scc1 L_w112
    s_waitcnt vmcnt(3)
L_w112:
    s_waitcnt vmcnt(5)
    buffer_load_dwordx4 v[72:75], v1, s[32:35], s72 offen offset:128 nt
    v_dot2c_f32_bf16 v31, v120, v40
    v_dot2c_f32_bf16 v31, v121, v41
    v_dot2c_f32_bf16 v31, v122, v42
    v_dot2c_f32_bf16 v31, v123, v43
    s_cbranch_vccnz L_w113
    s_waitcnt vmcnt(4)
    s_cmp_eq_u32 s31, 0
    s_cbranch_scc1 L_w113
    s_waitcnt vmcnt(3)
L_w113:
    s_waitcnt vmcnt(5)
    buffer_load_dwordx4 v[76:79], v1, s[32:35], s72 offen offset:256 nt
    v_dot2c_f32_bf16 v31, v124, v44
    v_dot2c_f32_bf16 v31, v125, v45
    v_dot2c_f32_bf16 v31, v126, v46
    v_dot2c_f32_bf16 v31, v127, v47
    s_cbranch_vccnz L_w114
    s_waitcnt vmcnt(4)
    s_cmp_eq_u32 s31, 0
    s_cbranch_scc1 L_w114
    s_waitcnt vmcnt(3)
L_w114:
    s_waitcnt vmcnt(5)
    ds_add_u32 v4, v3 offset:21952
    v_mov_b32 v53, 0
    ds_read_b32 v53, v53 offset:21936
    s_mov_b32 s72, 67584
    buffer_load_dwordx4 v[80:83], v1, s[32:35], s72 offen offset:0 nt
    v_mov_b32 v32, 0
    v_dot2c_f32_bf16 v32, v56, v36
    v_dot2c_f32_bf16 v32, v57, v37
    v_dot2c_f32_bf16 v32, v58, v38
    v_dot2c_f32_bf16 v32, v59, v39
    s_cbranch_vccnz L_w115
    s_waitcnt vmcnt(4)
    s_cmp_eq_u32 s31, 0
    s_cbranch_scc1 L_w115
    s_waitcnt vmcnt(3)
L_w115:
    s_waitcnt vmcnt(5)
    buffer_load_dwordx4 v[84:87], v1, s[32:35], s72 offen offset:128 nt
    v_dot2c_f32_bf16 v32, v60, v40
    v_dot2c_f32_bf16 v32, v61, v41
    v_dot2c_f32_bf16 v32, v62, v42
    v_dot2c_f32_bf16 v32, v63, v43
    s_cbranch_vccnz L_w116
    s_waitcnt vmcnt(4)
    s_cmp_eq_u32 s31, 0
    s_cbranch_scc1 L_w116
    s_waitcnt vmcnt(3)
L_w116:
    s_waitcnt vmcnt(5)
    s_waitcnt lgkmcnt(0)
    v_readfirstlane_b32 s30, v53
    s_and_b32 s31, s30, 1
    s_lshr_b32 s30, s30, 1
    s_cmp_lg_u32 s30, 0
    s_cselect_b64 vcc, -1, 0
    buffer_load_dwordx4 v[88:91], v1, s[32:35], s72 offen offset:256 nt
    v_dot2c_f32_bf16 v32, v64, v44
    v_dot2c_f32_bf16 v32, v65, v45
    v_dot2c_f32_bf16 v32, v66, v46
    v_dot2c_f32_bf16 v32, v67, v47
    s_cbranch_vccnz L_w117
    s_waitcnt vmcnt(4)
    s_cmp_eq_u32 s31, 0
    s_cbranch_scc1 L_w117
    s_waitcnt vmcnt(3)
L_w117:
    s_waitcnt vmcnt(5)
    ds_add_u32 v4, v3 offset:21952
    s_mov_b32 s72, 70656
    buffer_load_dwordx4 v[92:95], v1, s[32:35], s72 offen offset:0 nt
    v_mov_b32 v33, 0
    v_dot2c_f32_bf16 v33, v68, v36
    v_dot2c_f32_bf16 v33, v69, v37
    v_dot2c_f32_bf16 v33, v70, v38
    v_dot2c_f32_bf16 v33, v71, v39
    s_cbranch_vccnz L_w118
    s_waitcnt vmcnt(4)
    s_cmp_eq_u32 s31, 0
    s_cbranch_scc1 L_w118
    s_waitcnt vmcnt(3)
L_w118:
    s_waitcnt vmcnt(5)
    buffer_load_dwordx4 v[96:99], v1, s[32:35], s72 offen offset:128 nt
    v_dot2c_f32_bf16 v33, v72, v40
    v_dot2c_f32_bf16 v33, v73, v41
    v_dot2c_f32_bf16 v33, v74, v42
    v_dot2c_f32_bf16 v33, v75, v43
    s_cbranch_vccnz L_w119
    s_waitcnt vmcnt(4)
    s_cmp_eq_u32 s31, 0
    s_cbranch_scc1 L_w119
    s_waitcnt vmcnt(3)
L_w119:
    s_waitcnt vmcnt(5)
    buffer_load_dwordx4 v[100:103], v1, s[32:35], s72 offen offset:256 nt
    v_dot2c_f32_bf16 v33, v76, v44
    v_dot2c_f32_bf16 v33, v77, v45
    v_dot2c_f32_bf16 v33, v78, v46
    v_dot2c_f32_bf16 v33, v79, v47
    s_cbranch_vccnz L_w120
    s_waitcnt vmcnt(4)
    s_cmp_eq_u32 s31, 0
    s_cbranch_scc1 L_w120
    s_waitcnt vmcnt(3)
L_w120:
    s_waitcnt vmcnt(5)
    ds_add_u32 v4, v3 offset:21952
    v_mov_b32 v53, 0
    ds_read_b32 v53, v53 offset:21936
    s_mov_b32 s72, 49152
    buffer_load_dwordx4 v[104:107], v1, s[36:39], s72 offen offset:0 nt
    v_mov_b32 v34, 0
    v_dot2c_f32_bf16 v34, v80, v36
    v_dot2c_f32_bf16 v34, v81, v37
    v_dot2c_f32_bf16 v34, v82, v38
    v_dot2c_f32_bf16 v34, v83, v39
    s_cbranch_vccnz L_w121
    s_waitcnt vmcnt(4)
    s_cmp_eq_u32 s31, 0
    s_cbranch_scc1 L_w121
    s_waitcnt vmcnt(3)
L_w121:
    s_waitcnt vmcnt(5)
    buffer_load_dwordx4 v[108:111], v1, s[36:39], s72 offen offset:128 nt
    v_dot2c_f32_bf16 v34, v84, v40
    v_dot2c_f32_bf16 v34, v85, v41
    v_dot2c_f32_bf16 v34, v86, v42
    v_dot2c_f32_bf16 v34, v87, v43
    s_cbranch_vccnz L_w122
    s_waitcnt vmcnt(4)
    s_cmp_eq_u32 s31, 0
    s_cbranch_scc1 L_w122
    s_waitcnt vmcnt(3)
L_w122:
    s_waitcnt vmcnt(5)
    s_waitcnt lgkmcnt(0)
    v_readfirstlane_b32 s30, v53
    s_and_b32 s31, s30, 1
    s_lshr_b32 s30, s30, 1
    s_cmp_lg_u32 s30, 0
    s_cselect_b64 vcc, -1, 0
    buffer_load_dwordx4 v[112:115], v1, s[36:39], s72 offen offset:256 nt
    v_dot2c_f32_bf16 v34, v88, v44
    v_dot2c_f32_bf16 v34, v89, v45
    v_dot2c_f32_bf16 v34, v90, v46
    v_dot2c_f32_bf16 v34, v91, v47
    s_cbranch_vccnz L_w123
    s_waitcnt vmcnt(4)
    s_cmp_eq_u32 s31, 0
    s_cbranch_scc1 L_w123
    s_waitcnt vmcnt(3)
L_w123:
    s_waitcnt vmcnt(5)
    ds_add_u32 v4, v3 offset:21952
    s_mov_b32 s72, 52224
    buffer_load_dwordx4 v[116:119], v1, s[36:39], s72 offen offset:0 nt
    v_mov_b32 v35, 0
    v_dot2c_f32_bf16 v35, v92, v36
    v_dot2c_f32_bf16 v35, v93, v37
    v_dot2c_f32_bf16 v35, v94, v38
    v_dot2c_f32_bf16 v35, v95, v39
    s_cbranch_vccnz L_w124
    s_waitcnt vmcnt(4)
    s_cmp_eq_u32 s31, 0
    s_cbranch_scc1 L_w124
    s_waitcnt vmcnt(3)
L_w124:
    s_waitcnt vmcnt(5)
    buffer_load_dwordx4 v[120:123], v1, s[36:39], s72 offen offset:128 nt
    v_dot2c_f32_bf16 v35, v96, v40
    v_dot2c_f32_bf16 v35, v97, v41
    v_dot2c_f32_bf16 v35, v98, v42
    v_dot2c_f32_bf16 v35, v99, v43
    s_cbranch_vccnz L_w125
    s_waitcnt vmcnt(4)
    s_cmp_eq_u32 s31, 0
    s_cbranch_scc1 L_w125
    s_waitcnt vmcnt(3)
L_w125:
    s_waitcnt vmcnt(5)
    buffer_load_dwordx4 v[124:127], v1, s[36:39], s72 offen offset:256 nt
    v_dot2c_f32_bf16 v35, v100, v44
    v_dot2c_f32_bf16 v35, v101, v45
    v_dot2c_f32_bf16 v35, v102, v46
    v_dot2c_f32_bf16 v35, v103, v47
    s_cbranch_vccnz L_w126
    s_waitcnt vmcnt(4)
    s_cmp_eq_u32 s31, 0
    s_cbranch_scc1 L_w126
    s_waitcnt vmcnt(3)
L_w126:
    s_waitcnt vmcnt(5)
    ds_add_u32 v4, v3 offset:21952
    v_mov_b32 v53, 0
    ds_read_b32 v53, v53 offset:21936
    s_mov_b32 s72, 55296
    buffer_load_dwordx4 v[56:59], v1, s[36:39], s72 offen offset:0 nt
    s_nop 2
    v_add_f32_dpp v28, v28, v28 quad_perm:[1,0,3,2] row_mask:0xf bank_mask:0xf
    v_add_f32_dpp v29, v29, v29 quad_perm:[1,0,3,2] row_mask:0xf bank_mask:0xf
    v_add_f32_dpp v30, v30, v30 quad_perm:[1,0,3,2] row_mask:0xf bank_mask:0xf
    v_add_f32_dpp v31, v31, v31 quad_perm:[1,0,3,2] row_mask:0xf bank_mask:0xf
    v_add_f32_dpp v32, v32, v32 quad_perm:[1,0,3,2] row_mask:0xf bank_mask:0xf
    v_add_f32_dpp v33, v33, v33 quad_perm:[1,0,3,2] row_mask:0xf bank_mask:0xf
    v_add_f32_dpp v34, v34, v34 quad_perm:[1,0,3,2] row_mask:0xf bank_mask:0xf
    v_add_f32_dpp v35, v35, v35 quad_perm:[1,0,3,2] row_mask:0xf bank_mask:0xf
    v_add_f32_dpp v28, v28, v28 quad_perm:[2,3,0,1] row_mask:0xf bank_mask:0xf
    v_add_f32_dpp v29, v29, v29 quad_perm:[2,3,0,1] row_mask:0xf bank_mask:0xf
    v_add_f32_dpp v30, v30, v30 quad_perm:[2,3,0,1] row_mask:0xf bank_mask:0xf
    v_add_f32_dpp v31, v31, v31 quad_perm:[2,3,0,1] row_mask:0xf bank_mask:0xf
    v_add_f32_dpp v32, v32, v32 quad_perm:[2,3,0,1] row_mask:0xf bank_mask:0xf
    v_add_f32_dpp v33, v33, v33 quad_perm:[2,3,0,1] row_mask:0xf bank_mask:0xf
    v_add_f32_dpp v34, v34, v34 quad_perm:[2,3,0,1] row_mask:0xf bank_mask:0xf
    v_add_f32_dpp v35, v35, v35 quad_perm:[2,3,0,1] row_mask:0xf bank_mask:0xf
    v_add_f32_dpp v28, v28, v28 row_half_mirror row_mask:0xf bank_mask:0xf
    v_add_f32_dpp v29, v29, v29 row_half_mirror row_mask:0xf bank_mask:0xf
    v_add_f32_dpp v30, v30, v30 row_half_mirror row_mask:0xf bank_mask:0xf
    v_add_f32_dpp v31, v31, v31 row_half_mirror row_mask:0xf bank_mask:0xf
    v_add_f32_dpp v32, v32, v32 row_half_mirror row_mask:0xf bank_mask:0xf
    v_add_f32_dpp v33, v33, v33 row_half_mirror row_mask:0xf bank_mask:0xf
    v_add_f32_dpp v34, v34, v34 row_half_mirror row_mask:0xf bank_mask:0xf
    v_add_f32_dpp v35, v35, v35 row_half_mirror row_mask:0xf bank_mask:0xf
    s_cbranch_vccnz L_w127
    s_waitcnt vmcnt(4)
    s_cmp_eq_u32 s31, 0
    s_cbranch_scc1 L_w127
    s_waitcnt vmcnt(3)
L_w127:
    s_waitcnt vmcnt(5)
    buffer_load_dwordx4 v[60:63], v1, s[36:39], s72 offen offset:128 nt
    v_max3_f32 v49, v28, v29, v30
    v_max3_f32 v50, v31, v32, v33
    v_max3_f32 v49, v49, v34, v35
    v_max_f32 v49, v49, v50
    s_nop 1
    v_max_f32_dpp v49, v49, v49 row_ror:8 row_mask:0xf bank_mask:0xf
    s_nop 1
    v_max_f32_dpp v49, v49, v49 row_bcast:15 row_mask:0xa bank_mask:0xf
    s_nop 1
    v_max_f32_dpp v49, v49, v49 row_bcast:31 row_mask:0xc bank_mask:0xf
    v_mul_f32 v49, s73, v49
    v_max_f32 v49, s74, v49
    v_mov_b32 v50, s73
    v_readlane_b32 s91, v49, 63
    v_mov_b32 v54, s74
    s_nop 0
    v_subrev_f32 v54, s91, v54
    v_exp_f32 v54, v54
    s_mov_b32 s74, s91
    s_cbranch_vccnz L_w128
    s_waitcnt vmcnt(4)
    s_cmp_eq_u32 s31, 0
    s_cbranch_scc1 L_w128
    s_waitcnt vmcnt(3)
L_w128:
    s_waitcnt vmcnt(5)
    s_waitcnt lgkmcnt(0)
    v_readfirstlane_b32 s30, v53
    s_and_b32 s31, s30, 1
    s_lshr_b32 s30, s30, 1
    s_cmp_lg_u32 s30, 0
    s_cselect_b64 vcc, -1, 0
    buffer_load_dwordx4 v[64:67], v1, s[36:39], s72 offen offset:256 nt
    v_fma_f32 v28, v28, v50, -s91
    v_fma_f32 v29, v29, v50, -s91
    v_fma_f32 v30, v30, v50, -s91
    v_fma_f32 v31, v31, v50, -s91
    v_fma_f32 v32, v32, v50, -s91
    v_fma_f32 v33, v33, v50, -s91
    v_fma_f32 v34, v34, v50, -s91
    v_fma_f32 v35, v35, v50, -s91
    v_exp_f32 v28, v28
    v_exp_f32 v29, v29
    v_exp_f32 v30, v30
    v_exp_f32 v31, v31
    v_exp_f32 v32, v32
    v_exp_f32 v33, v33
    v_exp_f32 v34, v34
    v_exp_f32 v35, v35
    s_cbranch_vccnz L_w129
    s_waitcnt vmcnt(4)
    s_cmp_eq_u32 s31, 0
    s_cbranch_scc1 L_w129
    s_waitcnt vmcnt(3)
L_w129:
    s_waitcnt vmcnt(5)
    ds_add_u32 v4, v3 offset:21952
    s_mov_b32 s72, 58368
    buffer_load_dwordx4 v[68:71], v1, s[36:39], s72 offen offset:0 nt
    v_add_f32 v49, v28, v29
    v_add_f32 v50, v30, v31
    v_add_f32 v51, v32, v33
    v_add_f32 v52, v34, v35
    v_add_f32 v49, v49, v50
    v_add_f32 v51, v51, v52
    v_add_f32 v49, v49, v51
    v_fma_f32 v48, v48, v54, v49
    v_mul_f32 v16, v16, v54
    v_mul_f32 v17, v17, v54
    v_mul_f32 v18, v18, v54
    v_mul_f32 v19, v19, v54
    v_mul_f32 v20, v20, v54
    v_mul_f32 v21, v21, v54
    v_mul_f32 v22, v22, v54
    v_mul_f32 v23, v23, v54
    v_mul_f32 v24, v24, v54
    v_mul_f32 v25, v25, v54
    v_mul_f32 v26, v26, v54
    v_mul_f32 v27, v27, v54
    v_cvt_pk_bf16_f32 v28, v28, v28
    v_cvt_pk_bf16_f32 v29, v29, v29
    v_cvt_pk_bf16_f32 v30, v30, v30
    v_cvt_pk_bf16_f32 v31, v31, v31
    v_cvt_pk_bf16_f32 v32, v32, v32
    v_cvt_pk_bf16_f32 v33, v33, v33
    v_cvt_pk_bf16_f32 v34, v34, v34
    v_cvt_pk_bf16_f32 v35, v35, v35
    s_cbranch_vccnz L_w130
    s_waitcnt vmcnt(4)
    s_cmp_eq_u32 s31, 0
    s_cbranch_scc1 L_w130
    s_waitcnt vmcnt(3)
L_w130:
    s_waitcnt vmcnt(5)
    buffer_load_dwordx4 v[72:75], v1, s[36:39], s72 offen offset:128 nt
    v_and_b32 v8, v12, v28
    v_and_b32 v9, v13, v28
    v_and_b32 v10, v14, v28
    v_and_b32 v11, v15, v28
    s_nop 1
    v_mfma_f32_16x16x32_bf16 v[16:19], v[104:107], v[8:11], v[16:19]
    v_mfma_f32_16x16x32_bf16 v[20:23], v[108:111], v[8:11], v[20:23]
    v_mfma_f32_16x16x32_bf16 v[24:27], v[112:115], v[8:11], v[24:27]
    v_and_b32 v8, v12, v29
    v_and_b32 v9, v13, v29
    v_and_b32 v10, v14, v29
    v_and_b32 v11, v15, v29
    s_nop 1
    s_cbranch_vccnz L_w131
    s_waitcnt vmcnt(4)
    s_cmp_eq_u32 s31, 0
    s_cbranch_scc1 L_w131
    s_waitcnt vmcnt(3)
L_w131:
    s_waitcnt vmcnt(5)
    buffer_load_dwordx4 v[76:79], v1, s[36:39], s72 offen offset:256 nt
    v_mfma_f32_16x16x32_bf16 v[16:19], v[116:119], v[8:11], v[16:19]
    v_mfma_f32_16x16x32_bf16 v[20:23], v[120:123], v[8:11], v[20:23]
    v_mfma_f32_16x16x32_bf16 v[24:27], v[124:127], v[8:11], v[24:27]
    s_cbranch_vccnz L_w132
    s_waitcnt vmcnt(4)
    s_cmp_eq_u32 s31, 0
    s_cbranch_scc1 L_w132
    s_waitcnt vmcnt(3)
L_w132:
    s_waitcnt vmcnt(5)
    ds_add_u32 v4, v3 offset:21952
    v_mov_b32 v53, 0
    ds_read_b32 v53, v53 offset:21936
    s_mov_b32 s72, 61440
    buffer_load_dwordx4 v[80:83], v1, s[36:39], s72 offen offset:0 nt
    v_and_b32 v8, v12, v30
    v_and_b32 v9, v13, v30
    v_and_b32 v10, v14, v30
    v_and_b32 v11, v15, v30
    s_nop 1
    v_mfma_f32_16x16x32_bf16 v[16:19], v[56:59], v[8:11], v[16:19]
    s_cbranch_vccnz L_w133
    s_waitcnt vmcnt(4)
    s_cmp_eq_u32 s31, 0
    s_cbranch_scc1 L_w133
    s_waitcnt vmcnt(3)
L_w133:
    s_waitcnt vmcnt(5)
    buffer_load_dwordx4 v[84:87], v1, s[36:39], s72 offen offset:128 nt
    v_mfma_f32_16x16x32_bf16 v[20:23], v[60:63], v[8:11], v[20:23]
    s_cbranch_vccnz L_w134
    s_waitcnt vmcnt(4)
    s_cmp_eq_u32 s31, 0
    s_cbranch_scc1 L_w134
    s_waitcnt vmcnt(3)
L_w134:
    s_waitcnt vmcnt(5)
    s_waitcnt lgkmcnt(0)
    v_readfirstlane_b32 s30, v53
    s_and_b32 s31, s30, 1
    s_lshr_b32 s30, s30, 1
    s_cmp_lg_u32 s30, 0
    s_cselect_b64 vcc, -1, 0
    buffer_load_dwordx4 v[88:91], v1, s[36:39], s72 offen offset:256 nt
    v_mfma_f32_16x16x32_bf16 v[24:27], v[64:67], v[8:11], v[24:27]
    s_cbranch_vccnz L_w135
    s_waitcnt vmcnt(4)
    s_cmp_eq_u32 s31, 0
    s_cbranch_scc1 L_w135
    s_waitcnt vmcnt(3)
L_w135:
    s_waitcnt vmcnt(5)
    ds_add_u32 v4, v3 offset:21952
    s_mov_b32 s72, 64512
    buffer_load_dwordx4 v[92:95], v1, s[36:39], s72 offen offset:0 nt
    v_and_b32 v8, v12, v31
    v_and_b32 v9, v13, v31
    v_and_b32 v10, v14, v31
    v_and_b32 v11, v15, v31
    s_nop 1
    v_mfma_f32_16x16x32_bf16 v[16:19], v[68:71], v[8:11], v[16:19]
    s_cbranch_vccnz L_w136
    s_waitcnt vmcnt(4)
    s_cmp_eq_u32 s31, 0
    s_cbranch_scc1 L_w136
    s_waitcnt vmcnt(3)
L_w136:
    s_waitcnt vmcnt(5)
    buffer_load_dwordx4 v[96:99], v1, s[36:39], s72 offen offset:128 nt
    v_mfma_f32_16x16x32_bf16 v[20:23], v[72:75], v[8:11], v[20:23]
    s_cbranch_vccnz L_w137
    s_waitcnt vmcnt(4)
    s_cmp_eq_u32 s31, 0
    s_cbranch_scc1 L_w137
    s_waitcnt vmcnt(3)
L_w137:
    s_waitcnt vmcnt(5)
    buffer_load_dwordx4 v[100:103], v1, s[36:39], s72 offen offset:256 nt
    v_mfma_f32_16x16x32_bf16 v[24:27], v[76:79], v[8:11], v[24:27]
    s_cbranch_vccnz L_w138
    s_waitcnt vmcnt(4)
    s_cmp_eq_u32 s31, 0
    s_cbranch_scc1 L_w138
    s_waitcnt vmcnt(3)
L_w138:
    s_waitcnt vmcnt(5)
    ds_add_u32 v4, v3 offset:21952
    v_mov_b32 v53, 0
    ds_read_b32 v53, v53 offset:21936
    s_mov_b32 s72, 67584
    buffer_load_dwordx4 v[104:107], v1, s[36:39], s72 offen offset:0 nt
    v_and_b32 v8, v12, v32
    v_and_b32 v9, v13, v32
    v_and_b32 v10, v14, v32
    v_and_b32 v11, v15, v32
    s_nop 1
    v_mfma_f32_16x16x32_bf16 v[16:19], v[80:83], v[8:11], v[16:19]
    s_cbranch_vccnz L_w139
    s_waitcnt vmcnt(4)
    s_cmp_eq_u32 s31, 0
    s_cbranch_scc1 L_w139
    s_waitcnt vmcnt(3)
L_w139:
    s_waitcnt vmcnt(5)
    buffer_load_dwordx4 v[108:111], v1, s[36:39], s72 offen offset:128 nt
    v_mfma_f32_16x16x32_bf16 v[20:23], v[84:87], v[8:11], v[20:23]
    s_cbranch_vccnz L_w140
    s_waitcnt vmcnt(4)
    s_cmp_eq_u32 s31, 0
    s_cbranch_scc1 L_w140
    s_waitcnt vmcnt(3)
L_w140:
    s_waitcnt vmcnt(5)
    s_waitcnt lgkmcnt(0)
    v_readfirstlane_b32 s30, v53
    s_and_b32 s31, s30, 1
    s_lshr_b32 s30, s30, 1
    s_cmp_lg_u32 s30, 0
    s_cselect_b64 vcc, -1, 0
    buffer_load_dwordx4 v[112:115], v1, s[36:39], s72 offen offset:256 nt
    v_mfma_f32_16x16x32_bf16 v[24:27], v[88:91], v[8:11], v[24:27]
    s_cbranch_vccnz L_w141
    s_waitcnt vmcnt(4)
    s_cmp_eq_u32 s31, 0
    s_cbranch_scc1 L_w141
    s_waitcnt vmcnt(3)
L_w141:
    s_waitcnt vmcnt(5)
    ds_add_u32 v4, v3 offset:21952
    s_mov_b32 s72, 70656
    buffer_load_dwordx4 v[116:119], v1, s[36:39], s72 offen offset:0 nt
    v_and_b32 v8, v12, v33
    v_and_b32 v9, v13, v33
    v_and_b32 v10, v14, v33
    v_and_b32 v11, v15, v33
    s_nop 1
    v_mfma_f32_16x16x32_bf16 v[16:19], v[92:95], v[8:11], v[16:19]
    s_cbranch_vccnz L_w142
    s_waitcnt vmcnt(4)
    s_cmp_eq_u32 s31, 0
    s_cbranch_scc1 L_w142
    s_waitcnt vmcnt(3)
L_w142:
    s_waitcnt vmcnt(5)
    buffer_load_dwordx4 v[120:123], v1, s[36:39], s72 offen offset:128 nt
    v_mfma_f32_16x16x32_bf16 v[20:23], v[96:99], v[8:11], v[20:23]
    s_cbranch_vccnz L_w143
    s_waitcnt vmcnt(4)
    s_cmp_eq_u32 s31, 0
    s_cbranch_scc1 L_w143
    s_waitcnt vmcnt(3)
L_w143:
    s_waitcnt vmcnt(5)
    buffer_load_dwordx4 v[124:127], v1, s[36:39], s72 offen offset:256 nt
    v_mfma_f32_16x16x32_bf16 v[24:27], v[100:103], v[8:11], v[24:27]
    s_cbranch_vccnz L_w144
    s_waitcnt vmcnt(4)
    s_cmp_eq_u32 s31, 0
    s_cbranch_scc1 L_w144
    s_waitcnt vmcnt(3)
L_w144:
    s_waitcnt vmcnt(5)
    ds_add_u32 v4, v3 offset:21952
    v_mov_b32 v53, 0
    ds_read_b32 v53, v53 offset:21936
    s_mov_b32 s72, 73728
    buffer_load_dwordx4 v[56:59], v1, s[32:35], s72 offen offset:0 nt
    v_and_b32 v8, v12, v34
    v_and_b32 v9, v13, v34
    v_and_b32 v10, v14, v34
    v_and_b32 v11, v15, v34
    s_nop 1
    v_mfma_f32_16x16x32_bf16 v[16:19], v[104:107], v[8:11], v[16:19]
    s_cbranch_vccnz L_w145
    s_waitcnt vmcnt(4)
    s_cmp_eq_u32 s31, 0
    s_cbranch_scc1 L_w145
    s_waitcnt vmcnt(3)
L_w145:
    s_waitcnt vmcnt(5)
    buffer_load_dwordx4 v[60:63], v1, s[32:35], s72 offen offset:128 nt
    v_mfma_f32_16x16x32_bf16 v[20:23], v[108:111], v[8:11], v[20:23]
    s_cbranch_vccnz L_w146
    s_waitcnt vmcnt(4)
    s_cmp_eq_u32 s31, 0
    s_cbranch_scc1 L_w146
    s_waitcnt vmcnt(3)
L_w146:
    s_waitcnt vmcnt(5)
    s_waitcnt lgkmcnt(0)
    v_readfirstlane_b32 s30, v53
    s_and_b32 s31, s30, 1
    s_lshr_b32 s30, s30, 1
    s_cmp_lg_u32 s30, 0
    s_cselect_b64 vcc, -1, 0
    buffer_load_dwordx4 v[64:67], v1, s[32:35], s72 offen offset:256 nt
    v_mfma_f32_16x16x32_bf16 v[24:27], v[112:115], v[8:11], v[24:27]
    s_cbranch_vccnz L_w147
    s_waitcnt vmcnt(4)
    s_cmp_eq_u32 s31, 0
    s_cbranch_scc1 L_w147
    s_waitcnt vmcnt(3)
L_w147:
    s_waitcnt vmcnt(5)
    ds_add_u32 v4, v3 offset:21952
    s_mov_b32 s72, 76800
    buffer_load_dwordx4 v[68:71], v1, s[32:35], s72 offen offset:0 nt
    v_and_b32 v8, v12, v35
    v_and_b32 v9, v13, v35
    v_and_b32 v10, v14, v35
    v_and_b32 v11, v15, v35
    s_nop 1
    v_mfma_f32_16x16x32_bf16 v[16:19], v[116:119], v[8:11], v[16:19]
    s_cbranch_vccnz L_w148
    s_waitcnt vmcnt(4)
    s_cmp_eq_u32 s31, 0
    s_cbranch_scc1 L_w148
    s_waitcnt vmcnt(3)
L_w148:
    s_waitcnt vmcnt(5)
    buffer_load_dwordx4 v[72:75], v1, s[32:35], s72 offen offset:128 nt
    v_mfma_f32_16x16x32_bf16 v[20:23], v[120:123], v[8:11], v[20:23]
    s_cbranch_vccnz L_w149
    s_waitcnt vmcnt(4)
    s_cmp_eq_u32 s31, 0
    s_cbranch_scc1 L_w149
    s_waitcnt vmcnt(3)
L_w149:
    s_waitcnt vmcnt(5)
    buffer_load_dwordx4 v[76:79], v1, s[32:35], s72 offen offset:256 nt
    v_mfma_f32_16x16x32_bf16 v[24:27], v[124:127], v[8:11], v[24:27]
    s_cbranch_vccnz L_w150
    s_waitcnt vmcnt(4)
    s_cmp_eq_u32 s31, 0
    s_cbranch_scc1 L_w150
    s_waitcnt vmcnt(3)
L_w150:
    s_waitcnt vmcnt(5)
    ds_add_u32 v4, v3 offset:21952
    v_mov_b32 v53, 0
    ds_read_b32 v53, v53 offset:21936
    s_mov_b32 s72, 79872
    buffer_load_dwordx4 v[80:83], v1, s[32:35], s72 offen offset:0 nt
    v_mov_b32 v28, 0
    v_dot2c_f32_bf16 v28, v56, v36
    v_dot2c_f32_bf16 v28, v57, v37
    v_dot2c_f32_bf16 v28, v58, v38
    v_dot2c_f32_bf16 v28, v59, v39
    s_cbranch_vccnz L_w151
    s_waitcnt vmcnt(4)
    s_cmp_eq_u32 s31, 0
    s_cbranch_scc1 L_w151
    s_waitcnt vmcnt(3)
L_w151:
    s_waitcnt vmcnt(5)
    buffer_load_dwordx4 v[84:87], v1, s[32:35], s72 offen offset:128 nt
    v_dot2c_f32_bf16 v28, v60, v40
    v_dot2c_f32_bf16 v28, v61, v41
    v_dot2c_f32_bf16 v28, v62, v42
    v_dot2c_f32_bf16 v28, v63, v43
    s_cbranch_vccnz L_w152
    s_waitcnt vmcnt(4)
    s_cmp_eq_u32 s31, 0
    s_cbranch_scc1 L_w152
    s_waitcnt vmcnt(3)
L_w152:
    s_waitcnt vmcnt(5)
    s_waitcnt lgkmcnt(0)
    v_readfirstlane_b32 s30, v53
    s_and_b32 s31, s30, 1
    s_lshr_b32 s30, s30, 1
    s_cmp_lg_u32 s30, 0
    s_cselect_b64 vcc, -1, 0
    buffer_load_dwordx4 v[88:91], v1, s[32:35], s72 offen offset:256 nt
    v_dot2c_f32_bf16 v28, v64, v44
    v_dot2c_f32_bf16 v28, v65, v45
    v_dot2c_f32_bf16 v28, v66, v46
    v_dot2c_f32_bf16 v28, v67, v47
    s_cbranch_vccnz L_w153
    s_waitcnt vmcnt(4)
    s_cmp_eq_u32 s31, 0
    s_cbranch_scc1 L_w153
    s_waitcnt vmcnt(3)
L_w153:
    s_waitcnt vmcnt(5)
    ds_add_u32 v4, v3 offset:21952
    s_mov_b32 s72, 82944
    buffer_load_dwordx4 v[92:95], v1, s[32:35], s72 offen offset:0 nt
    v_mov_b32 v29, 0
    v_dot2c_f32_bf16 v29, v68, v36
    v_dot2c_f32_bf16 v29, v69, v37
    v_dot2c_f32_bf16 v29, v70, v38
    v_dot2c_f32_bf16 v29, v71, v39
    s_cbranch_vccnz L_w154
    s_waitcnt vmcnt(4)
    s_cmp_eq_u32 s31, 0
    s_cbranch_scc1 L_w154
    s_waitcnt vmcnt(3)
L_w154:
    s_waitcnt vmcnt(5)
    buffer_load_dwordx4 v[96:99], v1, s[32:35], s72 offen offset:128 nt
    v_dot2c_f32_bf16 v29, v72, v40
    v_dot2c_f32_bf16 v29, v73, v41
    v_dot2c_f32_bf16 v29, v74, v42
    v_dot2c_f32_bf16 v29, v75, v43
    s_cbranch_vccnz L_w155
    s_waitcnt vmcnt(4)
    s_cmp_eq_u32 s31, 0
    s_cbranch_scc1 L_w155
    s_waitcnt vmcnt(3)
L_w155:
    s_waitcnt vmcnt(5)
    buffer_load_dwordx4 v[100:103], v1, s[32:35], s72 offen offset:256 nt
    v_dot2c_f32_bf16 v29, v76, v44
    v_dot2c_f32_bf16 v29, v77, v45
    v_dot2c_f32_bf16 v29, v78, v46
    v_dot2c_f32_bf16 v29, v79, v47
    s_cbranch_vccnz L_w156
    s_waitcnt vmcnt(4)
    s_cmp_eq_u32 s31, 0
    s_cbranch_scc1 L_w156
    s_waitcnt vmcnt(3)
L_w156:
    s_waitcnt vmcnt(5)
    ds_add_u32 v4, v3 offset:21952
    v_mov_b32 v53, 0
    ds_read_b32 v53, v53 offset:21936
    s_mov_b32 s72, 86016
    buffer_load_dwordx4 v[104:107], v1, s[32:35], s72 offen offset:0 nt
    v_mov_b32 v30, 0
    v_dot2c_f32_bf16 v30, v80, v36
    v_dot2c_f32_bf16 v30, v81, v37
    v_dot2c_f32_bf16 v30, v82, v38
    v_dot2c_f32_bf16 v30, v83, v39
    s_cbranch_vccnz L_w157
    s_waitcnt vmcnt(4)
    s_cmp_eq_u32 s31, 0
    s_cbranch_scc1 L_w157
    s_waitcnt vmcnt(3)
L_w157:
    s_waitcnt vmcnt(5)
    buffer_load_dwordx4 v[108:111], v1, s[32:35], s72 offen offset:128 nt
    v_dot2c_f32_bf16 v30, v84, v40
    v_dot2c_f32_bf16 v30, v85, v41
    v_dot2c_f32_bf16 v30, v86, v42
    v_dot2c_f32_bf16 v30, v87, v43
    s_cbranch_vccnz L_w158
    s_waitcnt vmcnt(4)
    s_cmp_eq_u32 s31, 0
    s_cbranch_scc1 L_w158
    s_waitcnt vmcnt(3)
L_w158:
    s_waitcnt vmcnt(5)
    s_waitcnt lgkmcnt(0)
    v_readfirstlane_b32 s30, v53
    s_and_b32 s31, s30, 1
    s_lshr_b32 s30, s30, 1
    s_cmp_lg_u32 s30, 0
    s_cselect_b64 vcc, -1, 0
    buffer_load_dwordx4 v[112:115], v1, s[32:35], s72 offen offset:256 nt
    v_dot2c_f32_bf16 v30, v88, v44
    v_dot2c_f32_bf16 v30, v89, v45
    v_dot2c_f32_bf16 v30, v90, v46
    v_dot2c_f32_bf16 v30, v91, v47
    s_cbranch_vccnz L_w159
    s_waitcnt vmcnt(4)
    s_cmp_eq_u32 s31, 0
    s_cbranch_scc1 L_w159
    s_waitcnt vmcnt(3)
L_w159:
    s_waitcnt vmcnt(5)
    ds_add_u32 v4, v3 offset:21952
    s_mov_b32 s72, 89088
    buffer_load_dwordx4 v[116:119], v1, s[32:35], s72 offen offset:0 nt
    v_mov_b32 v31, 0
    v_dot2c_f32_bf16 v31, v92, v36
    v_dot2c_f32_bf16 v31, v93, v37
    v_dot2c_f32_bf16 v31, v94, v38
    v_dot2c_f32_bf16 v31, v95, v39
    s_cbranch_vccnz L_w160
    s_waitcnt vmcnt(4)
    s_cmp_eq_u32 s31, 0
    s_cbranch_scc1 L_w160
    s_waitcnt vmcnt(3)
L_w160:
    s_waitcnt vmcnt(5)
    buffer_load_dwordx4 v[120:123], v1, s[32:35], s72 offen offset:128 nt
    v_dot2c_f32_bf16 v31, v96, v40
    v_dot2c_f32_bf16 v31, v97, v41
    v_dot2c_f32_bf16 v31, v98, v42
    v_dot2c_f32_bf16 v31, v99, v43
    s_cbranch_vccnz L_w161
    s_waitcnt vmcnt(4)
    s_cmp_eq_u32 s31, 0
    s_cbranch_scc1 L_w161
    s_waitcnt vmcnt(3)
L_w161:
    s_waitcnt vmcnt(5)
    buffer_load_dwordx4 v[124:127], v1, s[32:35], s72 offen offset:256 nt
    v_dot2c_f32_bf16 v31, v100, v44
    v_dot2c_f32_bf16 v31, v101, v45
    v_dot2c_f32_bf16 v31, v102, v46
    v_dot2c_f32_bf16 v31, v103, v47
    s_cbranch_vccnz L_w162
    s_waitcnt vmcnt(4)
    s_cmp_eq_u32 s31, 0
    s_cbranch_scc1 L_w162
    s_waitcnt vmcnt(3)
L_w162:
    s_waitcnt vmcnt(5)
    ds_add_u32 v4, v3 offset:21952
    v_mov_b32 v53, 0
    ds_read_b32 v53, v53 offset:21936
    s_mov_b32 s72, 92160
    buffer_load_dwordx4 v[56:59], v1, s[32:35], s72 offen offset:0 nt
    v_mov_b32 v32, 0
    v_dot2c_f32_bf16 v32, v104, v36
    v_dot2c_f32_bf16 v32, v105, v37
    v_dot2c_f32_bf16 v32, v106, v38
    v_dot2c_f32_bf16 v32, v107, v39
    s_cbranch_vccnz L_w163
    s_waitcnt vmcnt(4)
    s_cmp_eq_u32 s31, 0
    s_cbranch_scc1 L_w163
    s_waitcnt vmcnt(3)
L_w163:
    s_waitcnt vmcnt(5)
    buffer_load_dwordx4 v[60:63], v1, s[32:35], s72 offen offset:128 nt
    v_dot2c_f32_bf16 v32, v108, v40
    v_dot2c_f32_bf16 v32, v109, v41
    v_dot2c_f32_bf16 v32, v110, v42
    v_dot2c_f32_bf16 v32, v111, v43
    s_cbranch_vccnz L_w164
    s_waitcnt vmcnt(4)
    s_cmp_eq_u32 s31, 0
    s_cbranch_scc1 L_w164
    s_waitcnt vmcnt(3)
L_w164:
    s_waitcnt vmcnt(5)
    s_waitcnt lgkmcnt(0)
    v_readfirstlane_b32 s30, v53
    s_and_b32 s31, s30, 1
    s_lshr_b32 s30, s30, 1
    s_cmp_lg_u32 s30, 0
    s_cselect_b64 vcc, -1, 0
    buffer_load_dwordx4 v[64:67], v1, s[32:35], s72 offen offset:256 nt
    v_dot2c_f32_bf16 v32, v112, v44
    v_dot2c_f32_bf16 v32, v113, v45
    v_dot2c_f32_bf16 v32, v114, v46
    v_dot2c_f32_bf16 v32, v115, v47
    s_cbranch_vccnz L_w165
    s_waitcnt vmcnt(4)
    s_cmp_eq_u32 s31, 0
    s_cbranch_scc1 L_w165
    s_waitcnt vmcnt(3)
L_w165:
    s_waitcnt vmcnt(5)
    ds_add_u32 v4, v3 offset:21952
    s_mov_b32 s72, 95232
    buffer_load_dwordx4 v[68:71], v1, s[32:35], s72 offen offset:0 nt
    v_mov_b32 v33, 0
    v_dot2c_f32_bf16 v33, v116, v36
    v_dot2c_f32_bf16 v33, v117, v37
    v_dot2c_f32_bf16 v33, v118, v38
    v_dot2c_f32_bf16 v33, v119, v39
    s_cbranch_vccnz L_w166
    s_waitcnt vmcnt(4)
    s_cmp_eq_u32 s31, 0
    s_cbranch_scc1 L_w166
    s_waitcnt vmcnt(3)
L_w166:
    s_waitcnt vmcnt(5)
    buffer_load_dwordx4 v[72:75], v1, s[32:35], s72 offen offset:128 nt
    v_dot2c_f32_bf16 v33, v120, v40
    v_dot2c_f32_bf16 v33, v121, v41
    v_dot2c_f32_bf16 v33, v122, v42
    v_dot2c_f32_bf16 v33, v123, v43
    s_cbranch_vccnz L_w167
    s_waitcnt vmcnt(4)
    s_cmp_eq_u32 s31, 0
    s_cbranch_scc1 L_w167
    s_waitcnt vmcnt(3)
L_w167:
    s_waitcnt vmcnt(5)
    buffer_load_dwordx4 v[76:79], v1, s[32:35], s72 offen offset:256 nt
    v_dot2c_f32_bf16 v33, v124, v44
    v_dot2c_f32_bf16 v33, v125, v45
    v_dot2c_f32_bf16 v33, v126, v46
    v_dot2c_f32_bf16 v33, v127, v47
    ds_add_u32 v4, v3 offset:21952
    s_mov_b32 s72, 73728
    buffer_load_dwordx4 v[80:83], v1, s[36:39], s72 offen offset:0 nt
    s_mov_b32 s72, 76800
    buffer_load_dwordx4 v[84:87], v1, s[36:39], s72 offen offset:0 nt
    s_mov_b32 s72, 79872
    buffer_load_dwordx4 v[88:91], v1, s[36:39], s72 offen offset:0 nt
    s_waitcnt vmcnt(8)
    s_mov_b32 s72, 82944
    buffer_load_dwordx4 v[92:95], v1, s[36:39], s72 offen offset:0 nt
    v_mov_b32 v34, 0
    v_dot2c_f32_bf16 v34, v56, v36
    v_dot2c_f32_bf16 v34, v57, v37
    v_dot2c_f32_bf16 v34, v58, v38
    v_dot2c_f32_bf16 v34, v59, v39
    s_waitcnt vmcnt(8)
    s_mov_b32 s72, 86016
    buffer_load_dwordx4 v[96:99], v1, s[36:39], s72 offen offset:0 nt
    v_dot2c_f32_bf16 v34, v60, v40
    v_dot2c_f32_bf16 v34, v61, v41
    v_dot2c_f32_bf16 v34, v62, v42
    v_dot2c_f32_bf16 v34, v63, v43
    s_waitcnt vmcnt(8)
    s_mov_b32 s72, 89088
    buffer_load_dwordx4 v[100:103], v1, s[36:39], s72 offen offset:0 nt
    v_dot2c_f32_bf16 v34, v64, v44
    v_dot2c_f32_bf16 v34, v65, v45
    v_dot2c_f32_bf16 v34, v66, v46
    v_dot2c_f32_bf16 v34, v67, v47
    s_waitcnt vmcnt(8)
    s_mov_b32 s72, 92160
    buffer_load_dwordx4 v[104:107], v1, s[36:39], s72 offen offset:0 nt
    v_mov_b32 v35, 0
    v_dot2c_f32_bf16 v35, v68, v36
    v_dot2c_f32_bf16 v35, v69, v37
    v_dot2c_f32_bf16 v35, v70, v38
    v_dot2c_f32_bf16 v35, v71, v39
    s_waitcnt vmcnt(8)
    s_mov_b32 s72, 95232
    buffer_load_dwordx4 v[108:111], v1, s[36:39], s72 offen offset:0 nt
    v_dot2c_f32_bf16 v35, v72, v40
    v_dot2c_f32_bf16 v35, v73, v41
    v_dot2c_f32_bf16 v35, v74, v42
    v_dot2c_f32_bf16 v35, v75, v43
    s_waitcnt vmcnt(8)
    s_mov_b32 s72, 73728
    buffer_load_dwordx4 v[112:115], v1, s[36:39], s72 offen offset:128 nt
    v_dot2c_f32_bf16 v35, v76, v44
    v_dot2c_f32_bf16 v35, v77, v45
    v_dot2c_f32_bf16 v35, v78, v46
    v_dot2c_f32_bf16 v35, v79, v47
    s_waitcnt vmcnt(8)
    s_mov_b32 s72, 76800
    buffer_load_dwordx4 v[116:119], v1, s[36:39], s72 offen offset:128 nt
    s_nop 2
    v_add_f32_dpp v28, v28, v28 quad_perm:[1,0,3,2] row_mask:0xf bank_mask:0xf
    v_add_f32_dpp v29, v29, v29 quad_perm:[1,0,3,2] row_mask:0xf bank_mask:0xf
    v_add_f32_dpp v30, v30, v30 quad_perm:[1,0,3,2] row_mask:0xf bank_mask:0xf
    v_add_f32_dpp v31, v31, v31 quad_perm:[1,0,3,2] row_mask:0xf bank_mask:0xf
    v_add_f32_dpp v32, v32, v32 quad_perm:[1,0,3,2] row_mask:0xf bank_mask:0xf
    v_add_f32_dpp v33, v33, v33 quad_perm:[1,0,3,2] row_mask:0xf bank_mask:0xf
    v_add_f32_dpp v34, v34, v34 quad_perm:[1,0,3,2] row_mask:0xf bank_mask:0xf
    v_add_f32_dpp v35, v35, v35 quad_perm:[1,0,3,2] row_mask:0xf bank_mask:0xf
    v_add_f32_dpp v28, v28, v28 quad_perm:[2,3,0,1] row_mask:0xf bank_mask:0xf
    v_add_f32_dpp v29, v29, v29 quad_perm:[2,3,0,1] row_mask:0xf bank_mask:0xf
    v_add_f32_dpp v30, v30, v30 quad_perm:[2,3,0,1] row_mask:0xf bank_mask:0xf
    v_add_f32_dpp v31, v31, v31 quad_perm:[2,3,0,1] row_mask:0xf bank_mask:0xf
    v_add_f32_dpp v32, v32, v32 quad_perm:[2,3,0,1] row_mask:0xf bank_mask:0xf
    v_add_f32_dpp v33, v33, v33 quad_perm:[2,3,0,1] row_mask:0xf bank_mask:0xf
    v_add_f32_dpp v34, v34, v34 quad_perm:[2,3,0,1] row_mask:0xf bank_mask:0xf
    v_add_f32_dpp v35, v35, v35 quad_perm:[2,3,0,1] row_mask:0xf bank_mask:0xf
    v_add_f32_dpp v28, v28, v28 row_half_mirror row_mask:0xf bank_mask:0xf
    v_add_f32_dpp v29, v29, v29 row_half_mirror row_mask:0xf bank_mask:0xf
    v_add_f32_dpp v30, v30, v30 row_half_mirror row_mask:0xf bank_mask:0xf
    v_add_f32_dpp v31, v31, v31 row_half_mirror row_mask:0xf bank_mask:0xf
    v_add_f32_dpp v32, v32, v32 row_half_mirror row_mask:0xf bank_mask:0xf
    v_add_f32_dpp v33, v33, v33 row_half_mirror row_mask:0xf bank_mask:0xf
    v_add_f32_dpp v34, v34, v34 row_half_mirror row_mask:0xf bank_mask:0xf
    v_add_f32_dpp v35, v35, v35 row_half_mirror row_mask:0xf bank_mask:0xf
    s_waitcnt vmcnt(8)
    s_mov_b32 s72, 79872
    buffer_load_dwordx4 v[120:123], v1, s[36:39], s72 offen offset:128 nt
    v_max3_f32 v49, v28, v29, v30
    v_max3_f32 v50, v31, v32, v33
    v_max3_f32 v49, v49, v34, v35
    v_max_f32 v49, v49, v50
    s_nop 1
    v_max_f32_dpp v49, v49, v49 row_ror:8 row_mask:0xf bank_mask:0xf
    s_nop 1
    v_max_f32_dpp v49, v49, v49 row_bcast:15 row_mask:0xa bank_mask:0xf
    s_nop 1
    v_max_f32_dpp v49, v49, v49 row_bcast:31 row_mask:0xc bank_mask:0xf
    v_mul_f32 v49, s73, v49
    v_max_f32 v49, s74, v49
    v_mov_b32 v50, s73
    v_readlane_b32 s91, v49, 63
    v_mov_b32 v54, s74
    s_nop 0
    v_subrev_f32 v54, s91, v54
    v_exp_f32 v54, v54
    s_mov_b32 s74, s91
    s_waitcnt vmcnt(8)
    s_mov_b32 s72, 82944
    buffer_load_dwordx4 v[124:127], v1, s[36:39], s72 offen offset:128 nt
    v_fma_f32 v28, v28, v50, -s91
    v_fma_f32 v29, v29, v50, -s91
    v_fma_f32 v30, v30, v50, -s91
    v_fma_f32 v31, v31, v50, -s91
    v_fma_f32 v32, v32, v50, -s91
    v_fma_f32 v33, v33, v50, -s91
    v_fma_f32 v34, v34, v50, -s91
    v_fma_f32 v35, v35, v50, -s91
    v_exp_f32 v28, v28
    v_exp_f32 v29, v29
    v_exp_f32 v30, v30
    v_exp_f32 v31, v31
    v_exp_f32 v32, v32
    v_exp_f32 v33, v33
    v_exp_f32 v34, v34
    v_exp_f32 v35, v35
    s_waitcnt vmcnt(8)
    s_mov_b32 s72, 86016
    buffer_load_dwordx4 v[56:59], v1, s[36:39], s72 offen offset:128 nt
    v_add_f32 v49, v28, v29
    v_add_f32 v50, v30, v31
    v_add_f32 v51, v32, v33
    v_add_f32 v52, v34, v35
    v_add_f32 v49, v49, v50
    v_add_f32 v51, v51, v52
    v_add_f32 v49, v49, v51
    v_fma_f32 v48, v48, v54, v49
    v_mul_f32 v16, v16, v54
    v_mul_f32 v17, v17, v54
    v_mul_f32 v18, v18, v54
    v_mul_f32 v19, v19, v54
    v_mul_f32 v20, v20, v54
    v_mul_f32 v21, v21, v54
    v_mul_f32 v22, v22, v54
    v_mul_f32 v23, v23, v54
    v_mul_f32 v24, v24, v54
    v_mul_f32 v25, v25, v54
    v_mul_f32 v26, v26, v54
    v_mul_f32 v27, v27, v54
    v_cvt_pk_bf16_f32 v28, v28, v28
    v_cvt_pk_bf16_f32 v29, v29, v29
    v_cvt_pk_bf16_f32 v30, v30, v30
    v_cvt_pk_bf16_f32 v31, v31, v31
    v_cvt_pk_bf16_f32 v32, v32, v32
    v_cvt_pk_bf16_f32 v33, v33, v33
    v_cvt_pk_bf16_f32 v34, v34, v34
    v_cvt_pk_bf16_f32 v35, v35, v35
    s_waitcnt vmcnt(8)
    s_mov_b32 s72, 89088
    buffer_load_dwordx4 v[60:63], v1, s[36:39], s72 offen offset:128 nt
    v_add_f32_dpp v48, v48, v48 row_ror:8 row_mask:0xf bank_mask:0xf
    s_nop 1
    v_add_f32_dpp v48, v48, v48 row_bcast:15 row_mask:0xa bank_mask:0xf
    s_nop 1
    v_add_f32_dpp v48, v48, v48 row_bcast:31 row_mask:0xc bank_mask:0xf
    s_nop 1
    v_readlane_b32 s75, v48, 63
    v_mov_b32 v50, s74
    s_lshl_b32 s69, s93, 3
    v_mov_b32 v49, s69
    v_mov_b32 v51, s75
    ds_write_b64 v49, v[50:51] offset:21888
    s_waitcnt vmcnt(8)
    s_mov_b32 s72, 92160
    buffer_load_dwordx4 v[64:67], v1, s[36:39], s72 offen offset:128 nt
    v_and_b32 v8, v12, v28
    v_and_b32 v9, v13, v28
    v_and_b32 v10, v14, v28
    v_and_b32 v11, v15, v28
    s_nop 1
    v_mfma_f32_16x16x32_bf16 v[16:19], v[80:83], v[8:11], v[16:19]
    v_and_b32 v8, v12, v29
    v_and_b32 v9, v13, v29
    v_and_b32 v10, v14, v29
    v_and_b32 v11, v15, v29
    s_nop 1
    v_mfma_f32_16x16x32_bf16 v[16:19], v[84:87], v[8:11], v[16:19]
    v_and_b32 v8, v12, v30
    v_and_b32 v9, v13, v30
    v_and_b32 v10, v14, v30
    v_and_b32 v11, v15, v30
    s_nop 1
    v_mfma_f32_16x16x32_bf16 v[16:19], v[88:91], v[8:11], v[16:19]
    s_waitcnt vmcnt(8)
    s_mov_b32 s72, 95232
    buffer_load_dwordx4 v[68:71], v1, s[36:39], s72 offen offset:128 nt
    s_waitcnt lgkmcnt(0)
    s_barrier
    v_and_b32 v8, v12, v31
    v_and_b32 v9, v13, v31
    v_and_b32 v10, v14, v31
    v_and_b32 v11, v15, v31
    s_nop 1
    v_mfma_f32_16x16x32_bf16 v[16:19], v[92:95], v[8:11], v[16:19]
    v_and_b32 v8, v12, v32
    v_and_b32 v9, v13, v32
    v_and_b32 v10, v14, v32
    v_and_b32 v11, v15, v32
    s_nop 1
    v_mfma_f32_16x16x32_bf16 v[16:19], v[96:99], v[8:11], v[16:19]
    v_and_b32 v8, v12, v33
    v_and_b32 v9, v13, v33
    v_and_b32 v10, v14, v33
    v_and_b32 v11, v15, v33
    s_nop 1
    s_waitcnt vmcnt(8)
    s_mov_b32 s72, 73728
    buffer_load_dwordx4 v[72:75], v1, s[36:39], s72 offen offset:256 nt
    v_mfma_f32_16x16x32_bf16 v[16:19], v[100:103], v[8:11], v[16:19]
    v_and_b32 v8, v12, v34
    v_and_b32 v9, v13, v34
    v_and_b32 v10, v14, v34
    v_and_b32 v11, v15, v34
    s_nop 1
    v_mfma_f32_16x16x32_bf16 v[16:19], v[104:107], v[8:11], v[16:19]
    v_and_b32 v8, v12, v35
    v_and_b32 v9, v13, v35
    v_and_b32 v10, v14, v35
    v_and_b32 v11, v15, v35
    s_nop 1
    v_mfma_f32_16x16x32_bf16 v[16:19], v[108:111], v[8:11], v[16:19]
    s_waitcnt vmcnt(8)
    s_mov_b32 s72, 76800
    buffer_load_dwordx4 v[76:79], v1, s[36:39], s72 offen offset:256 nt
    v_and_b32 v8, v12, v28
    v_and_b32 v9, v13, v28
    v_and_b32 v10, v14, v28
    v_and_b32 v11, v15, v28
    s_nop 1
    v_mfma_f32_16x16x32_bf16 v[20:23], v[112:115], v[8:11], v[20:23]
    s_waitcnt vmcnt(8)
    s_mov_b32 s72, 79872
    buffer_load_dwordx4 v[80:83], v1, s[36:39], s72 offen offset:256 nt
    v_and_b32 v8, v12, v29
    v_and_b32 v9, v13, v29
    v_and_b32 v10, v14, v29
    v_and_b32 v11, v15, v29
    s_nop 1
    v_mfma_f32_16x16x32_bf16 v[20:23], v[116:119], v[8:11], v[20:23]
    s_waitcnt vmcnt(8)
    s_mov_b32 s72, 82944
    buffer_load_dwordx4 v[84:87], v1, s[36:39], s72 offen offset:256 nt
    v_and_b32 v8, v12, v30
    v_and_b32 v9, v13, v30
    v_and_b32 v10, v14, v30
    v_and_b32 v11, v15, v30
    s_nop 1
    v_mfma_f32_16x16x32_bf16 v[20:23], v[120:123], v[8:11], v[20:23]
    s_waitcnt vmcnt(8)
    s_mov_b32 s72, 86016
    buffer_load_dwordx4 v[88:91], v1, s[36:39], s72 offen offset:256 nt
    v_and_b32 v8, v12, v31
    v_and_b32 v9, v13, v31
    v_and_b32 v10, v14, v31
    v_and_b32 v11, v15, v31
    s_nop 1
    v_mfma_f32_16x16x32_bf16 v[20:23], v[124:127], v[8:11], v[20:23]
    s_waitcnt vmcnt(8)
    s_mov_b32 s72, 89088
    buffer_load_dwordx4 v[92:95], v1, s[36:39], s72 offen offset:256 nt
    v_and_b32 v8, v12, v32
    v_and_b32 v9, v13, v32
    v_and_b32 v10, v14, v32
    v_and_b32 v11, v15, v32
    s_nop 1
    v_mfma_f32_16x16x32_bf16 v[20:23], v[56:59], v[8:11], v[20:23]
    s_waitcnt vmcnt(8)
    s_mov_b32 s72, 92160
    buffer_load_dwordx4 v[96:99], v1, s[36:39], s72 offen offset:256 nt
    v_and_b32 v8, v12, v33
    v_and_b32 v9, v13, v33
    v_and_b32 v10, v14, v33
    v_and_b32 v11, v15, v33
    s_nop 1
    v_mfma_f32_16x16x32_bf16 v[20:23], v[60:63], v[8:11], v[20:23]
    s_waitcnt vmcnt(8)
    s_mov_b32 s72, 95232
    buffer_load_dwordx4 v[100:103], v1, s[36:39], s72 offen offset:256 nt
    v_and_b32 v8, v12, v34
    v_and_b32 v9, v13, v34
    v_and_b32 v10, v14, v34
    v_and_b32 v11, v15, v34
    s_nop 1
    v_mfma_f32_16x16x32_bf16 v[20:23], v[64:67], v[8:11], v[20:23]
    s_waitcnt vmcnt(8)
    v_and_b32 v8, v12, v35
    v_and_b32 v9, v13, v35
    v_and_b32 v10, v14, v35
    v_and_b32 v11, v15, v35
    s_nop 1
    v_mfma_f32_16x16x32_bf16 v[20:23], v[68:71], v[8:11], v[20:23]
    s_nop 6
    s_mov_b64 exec, s[78:79]
    ds_write_b128 v2, v[16:19] offset:0
    ds_write_b128 v2, v[20:23] offset:256
    s_mov_b64 exec, -1
    s_waitcnt lgkmcnt(0)
    s_barrier
    v_lshrrev_b32 v36, 3, v0
    v_mul_u32_u24 v36, 2560, v36
    v_bfe_u32 v37, v0, 2, 1
    v_mul_u32_u24 v37, 1280, v37
    v_add_u32 v36, v36, v37
    v_and_b32 v37, 3, v0
    v_lshl_add_u32 v36, v37, 4, v36
    s_waitcnt vmcnt(7)
    v_and_b32 v8, v12, v28
    v_and_b32 v9, v13, v28
    v_and_b32 v10, v14, v28
    v_and_b32 v11, v15, v28
    s_nop 1
    v_mfma_f32_16x16x32_bf16 v[24:27], v[72:75], v[8:11], v[24:27]
    v_and_b32 v8, v12, v29
    v_and_b32 v9, v13, v29
    v_and_b32 v10, v14, v29
    v_and_b32 v11, v15, v29
    s_nop 1
    s_waitcnt vmcnt(6)
    v_mfma_f32_16x16x32_bf16 v[24:27], v[76:79], v[8:11], v[24:27]
    v_and_b32 v8, v12, v30
    v_and_b32 v9, v13, v30
    v_and_b32 v10, v14, v30
    v_and_b32 v11, v15, v30
    s_nop 1
    s_waitcnt vmcnt(5)
    v_mfma_f32_16x16x32_bf16 v[24:27], v[80:83], v[8:11], v[24:27]
    v_and_b32 v8, v12, v31
    v_and_b32 v9, v13, v31
    v_and_b32 v10, v14, v31
    v_and_b32 v11, v15, v31
    s_nop 1
    s_waitcnt vmcnt(4)
    v_mfma_f32_16x16x32_bf16 v[24:27], v[84:87], v[8:11], v[24:27]
    v_and_b32 v8, v12, v32
    v_and_b32 v9, v13, v32
    v_and_b32 v10, v14, v32
    v_and_b32 v11, v15, v32
    s_nop 1
    s_waitcnt vmcnt(3)
    v_mfma_f32_16x16x32_bf16 v[24:27], v[88:91], v[8:11], v[24:27]
    v_and_b32 v8, v12, v33
    v_and_b32 v9, v13, v33
    v_and_b32 v10, v14, v33
    v_and_b32 v11, v15, v33
    s_nop 1
    s_waitcnt vmcnt(2)
    v_mfma_f32_16x16x32_bf16 v[24:27], v[92:95], v[8:11], v[24:27]
    v_and_b32 v8, v12, v34
    v_and_b32 v9, v13, v34
    v_and_b32 v10, v14, v34
    v_and_b32 v11, v15, v34
    s_nop 1
    s_waitcnt vmcnt(1)
    v_mfma_f32_16x16x32_bf16 v[24:27], v[96:99], v[8:11], v[24:27]
    v_and_b32 v8, v12, v35
    v_and_b32 v9, v13, v35
    v_and_b32 v10, v14, v35
    v_and_b32 v11, v15, v35
    s_nop 1
    s_waitcnt vmcnt(0)
    v_mfma_f32_16x16x32_bf16 v[24:27], v[100:103], v[8:11], v[24:27]
    s_nop 6
    s_mov_b64 exec, s[78:79]
    ds_write_b128 v2, v[24:27] offset:512
    s_mov_b64 exec, -1
    s_waitcnt lgkmcnt(0)
    s_barrier
    s_cmp_ge_u32 s2, 40
    s_cbranch_scc1 L_fin
    buffer_load_dwordx4 v[64:67], v36, s[52:55], s96 offen sc1
    v_mov_b32 v56, v36
    s_setprio 0
    s_branch L_b5
L_help:
    s_and_b32 s72, s68, -4
    s_cmp_eq_u32 s64, 15
    s_cbranch_scc1 L_hG
    v_and_b32 v6, 63, v0
    v_lshlrev_b32 v7, 4, v6
    v_mov_b32 v8, 0
    v_mov_b32 v9, 0
    v_mov_b32 v10, 0
    v_mov_b32 v11, 0
    ds_write_b128 v8, v[8:11] offset:21920
    ds_write_b32 v8, v8 offset:21936
    v_lshlrev_b32 v12, 2, v6
    ds_write_b32 v12, v8 offset:21952
    s_and_b32 s69, s2, 7
    s_lshl_b32 s69, s69, 8
    v_lshl_add_u32 v12, v6, 2, s69
    s_mov_b32 s73, 884736
    s_and_b32 s71, s68, -4
    s_add_u32 s69, s67, 0
    s_and_b32 s69, s69, 3
    s_add_u32 s69, s69, s71
    s_mul_i32 s69, s69, 768
    s_add_u32 s80, s69, 688128
    s_add_u32 s69, s67, 1
    s_and_b32 s69, s69, 3
    s_add_u32 s69, s69, s71
    s_mul_i32 s69, s69, 768
    s_add_u32 s81, s69, 688128
    s_add_u32 s69, s67, 2
    s_and_b32 s69, s69, 3
    s_add_u32 s69, s69, s71
    s_mul_i32 s69, s69, 768
    s_add_u32 s82, s69, 688128
    s_add_u32 s69, s67, 3
    s_and_b32 s69, s69, 3
    s_add_u32 s69, s69, s71
    s_mul_i32 s69, s69, 768
    s_add_u32 s83, s69, 688128
    s_waitcnt lgkmcnt(0)
    s_mov_b32 s52, s28
    s_and_b32 s53, s29, 0xffff
    s_mov_b32 s54, 917504
    s_mov_b32 s55, 0x20000
    s_mov_b32 s56, s24
    s_and_b32 s57, s25, 0xffff
    s_mov_b32 s58, 2560
    s_mov_b32 s59, 0x20000
    s_mov_b32 s60, s26
    s_and_b32 s61, s27, 0xffff
    s_mov_b32 s62, 256
    s_mov_b32 s63, 0x20000
    s_bfe_u32 s97, s2, 0x10002
    s_xor_b32 s97, s97, 1
    s_lshr_b32 s98, s2, 3
    s_lshl_b32 s98, s98, 2
    s_and_b32 s99, s2, 3
    s_add_u32 s98, s98, s99
    s_lshl_b32 s98, s98, 6
    s_mul_i32 s96, s97, 327680
    s_add_u32 s96, s96, s98
    s_mul_i32 s99, s97, 1280
    s_add_u32 s98, s98, s99
    s_lshl_b32 s97, s97, 10
    s_add_u32 s97, s97, 655360
    s_mov_b32 s99, 0
    s_mov_b32 exec_hi, 0xffff
    buffer_load_dwordx4 v[112:115], v7, s[52:55], s80 offen sc1
    buffer_load_dwordx4 v[116:119], v7, s[52:55], s81 offen sc1
    buffer_load_dwordx4 v[120:123], v7, s[52:55], s82 offen sc1
    buffer_load_dwordx4 v[124:127], v7, s[52:55], s83 offen sc1
    s_mov_b64 exec, 0xffffffff
    buffer_load_dword v13, v12, s[52:55], s73 offen sc0
    s_mov_b32 exec_lo, -1
    s_mov_b32 exec_hi, 0xffff
    s_barrier
    v_lshrrev_b32 v10, 3, v6
    v_and_b32 v6, 7, v6
    v_lshlrev_b32 v6, 1, v6
    v_lshl_add_u32 v6, v10, 6, v6
    v_mov_b32 v9, 1
    s_lshl_b32 s70, s68, 3
    s_add_u32 s70, s70, 655360
    s_waitcnt vmcnt(0)
    v_not_b32 v112, v112
    v_not_b32 v113, v113
    v_not_b32 v114, v114
    v_not_b32 v115, v115
    v_not_b32 v116, v116
    v_not_b32 v117, v117
    v_not_b32 v118, v118
    v_not_b32 v119, v119
    v_not_b32 v120, v120
    v_not_b32 v121, v121
    v_not_b32 v122, v122
    v_not_b32 v123, v123
    v_not_b32 v124, v124
    v_not_b32 v125, v125
    v_not_b32 v126, v126
    v_not_b32 v127, v127
    s_mov_b32 s77, 0
L_parts:
    ds_read_b32 v10, v8 offset:21920
    s_add_u32 s77, s77, 1
    s_waitcnt lgkmcnt(0)
    v_readfirstlane_b32 s69, v10
    s_cmp_ge_u32 s77, 0x40000
    s_cbranch_scc1 L_parts_done
    s_cmp_eq_u32 s69, 10
    s_cbranch_scc0 L_parts
L_parts_done:
    ds_read_b128 v[32:35], v7 offset:0
    ds_read_b128 v[36:39], v7 offset:768
    ds_read_b128 v[40:43], v7 offset:1536
    ds_read_b128 v[44:47], v7 offset:2304
    ds_read_b128 v[48:51], v7 offset:3072
    ds_read_b128 v[52:55], v7 offset:3840
    ds_read_b128 v[56:59], v7 offset:4608
    ds_read_b128 v[60:63], v7 offset:5376
    ds_read_b128 v[64:67], v7 offset:6144
    ds_read_b128 v[68:71], v7 offset:6912
    ds_read_b128 v[72:75], v7 offset:7680
    ds_read_b128 v[76:79], v7 offset:8448
    ds_read_b128 v[80:83], v7 offset:9216
    ds_read_b128 v[84:87], v7 offset:9984
    ds_read_b128 v[88:91], v7 offset:10752
    ds_read_b128 v[92:95], v7 offset:11520
    ds_read_b128 v[96:99], v7 offset:12288
    ds_read_b128 v[100:103], v7 offset:13056
    ds_read_b128 v[104:107], v7 offset:13824
    ds_read_b128 v[108:111], v7 offset:14592
    s_waitcnt lgkmcnt(15)
    v_add_f32 v32, v32, v36
    v_add_f32 v33, v33, v37
    v_add_f32 v34, v34, v38
    v_add_f32 v35, v35, v39
    s_waitcnt lgkmcnt(15)
    v_add_f32 v40, v40, v44
    v_add_f32 v41, v41, v45
    v_add_f32 v42, v42, v46
    v_add_f32 v43, v43, v47
    v_add_f32 v32, v32, v40
    v_add_f32 v33, v33, v41
    v_add_f32 v34, v34, v42
    v_add_f32 v35, v35, v43
    s_waitcnt lgkmcnt(14)
    v_add_f32 v48, v48, v52
    v_add_f32 v49, v49, v53
    v_add_f32 v50, v50, v54
    v_add_f32 v51, v51, v55
    s_waitcnt lgkmcnt(12)
    v_add_f32 v56, v56, v60
    v_add_f32 v57, v57, v61
    v_add_f32 v58, v58, v62
    v_add_f32 v59, v59, v63
    v_add_f32 v48, v48, v56
    v_add_f32 v49, v49, v57
    v_add_f32 v50, v50, v58
    v_add_f32 v51, v51, v59
    v_add_f32 v32, v32, v48
    v_add_f32 v33, v33, v49
    v_add_f32 v34, v34, v50
    v_add_f32 v35, v35, v51
    s_waitcnt lgkmcnt(10)
    v_add_f32 v64, v64, v68
    v_add_f32 v65, v65, v69
    v_add_f32 v66, v66, v70
    v_add_f32 v67, v67, v71
    s_waitcnt lgkmcnt(8)
    v_add_f32 v72, v72, v76
    v_add_f32 v73, v73, v77
    v_add_f32 v74, v74, v78
    v_add_f32 v75, v75, v79
    v_add_f32 v64, v64, v72
    v_add_f32 v65, v65, v73
    v_add_f32 v66, v66, v74
    v_add_f32 v67, v67, v75
    s_waitcnt lgkmcnt(6)
    v_add_f32 v80, v80, v84
    v_add_f32 v81, v81, v85
    v_add_f32 v82, v82, v86
    v_add_f32 v83, v83, v87
    s_waitcnt lgkmcnt(4)
    v_add_f32 v88, v88, v92
    v_add_f32 v89, v89, v93
    v_add_f32 v90, v90, v94
    v_add_f32 v91, v91, v95
    v_add_f32 v80, v80, v88
    v_add_f32 v81, v81, v89
    v_add_f32 v82, v82, v90
    v_add_f32 v83, v83, v91
    v_add_f32 v64, v64, v80
    v_add_f32 v65, v65, v81
    v_add_f32 v66, v66, v82
    v_add_f32 v67, v67, v83
    s_waitcnt lgkmcnt(2)
    v_add_f32 v96, v96, v100
    v_add_f32 v97, v97, v101
    v_add_f32 v98, v98, v102
    v_add_f32 v99, v99, v103
    s_waitcnt lgkmcnt(0)
    v_add_f32 v104, v104, v108
    v_add_f32 v105, v105, v109
    v_add_f32 v106, v106, v110
    v_add_f32 v107, v107, v111
    v_add_f32 v96, v96, v104
    v_add_f32 v97, v97, v105
    v_add_f32 v98, v98, v106
    v_add_f32 v99, v99, v107
    v_add_f32 v64, v64, v96
    v_add_f32 v65, v65, v97
    v_add_f32 v66, v66, v98
    v_add_f32 v67, v67, v99
    v_add_f32 v32, v32, v64
    v_add_f32 v33, v33, v65
    v_add_f32 v34, v34, v66
    v_add_f32 v35, v35, v67
    v_bfi_b32 v16, 1, v112, v32
    v_bfi_b32 v17, 1, v113, v33
    v_bfi_b32 v18, 1, v114, v34
    v_bfi_b32 v19, 1, v115, v35
    buffer_store_dwordx4 v[16:19], v7, s[52:55], s80 offen sc1
    s_waitcnt vmcnt(0)
    s_mov_b32 s77, 0
    s_mov_b32 s74, 0
L_qpoll:
    buffer_load_dwordx4 v[20:23], v7, s[52:55], s81 offen sc1
    buffer_load_dwordx4 v[24:27], v7, s[52:55], s82 offen sc1
    buffer_load_dwordx4 v[28:31], v7, s[52:55], s83 offen sc1
    s_cmp_lt_u32 s77, 2
    s_cbranch_scc1 L_qp1
    buffer_load_dword v11, v8, s[60:63], s72 offen sc1
L_qp1:
    s_waitcnt vmcnt(0)
    ds_write_b32 v8, v9 offset:21928
    v_xor_b32 v36, v20, v116
    v_xor_b32 v37, v21, v117
    v_xor_b32 v38, v22, v118
    v_xor_b32 v39, v23, v119
    v_xor_b32 v40, v24, v120
    v_xor_b32 v41, v25, v121
    v_xor_b32 v42, v26, v122
    v_xor_b32 v43, v27, v123
    v_xor_b32 v44, v28, v124
    v_xor_b32 v45, v29, v125
    v_xor_b32 v46, v30, v126
    v_xor_b32 v47, v31, v127
    v_or3_b32 v36, v36, v40, v44
    v_or3_b32 v37, v37, v41, v45
    v_or3_b32 v38, v38, v42, v46
    v_or3_b32 v39, v39, v43, v47
    v_or3_b32 v36, v36, v37, v38
    v_and_or_b32 v36, v39, 1, v36
    v_and_b32 v36, 1, v36
    v_cmp_ne_u32 vcc, 0, v36
    v_readfirstlane_b32 s69, v11
    s_add_u32 s77, s77, 1
    s_cbranch_vccz L_qpoll_done
    s_cmp_lg_u32 s74, 0
    s_cbranch_scc1 L_qpoll_done
    s_cmp_ge_u32 s69, 4
    s_cselect_b32 s74, 1, 0
    s_cmp_lt_u32 s77, 0x8000
    s_cbranch_scc1 L_qpoll
L_qpoll_done:
    v_and_b32 v16, -2, v16
    v_and_b32 v17, -2, v17
    v_and_b32 v18, -2, v18
    v_and_b32 v19, -2, v19
    v_and_b32 v20, -2, v20
    v_and_b32 v21, -2, v21
    v_and_b32 v22, -2, v22
    v_and_b32 v23, -2, v23
    v_and_b32 v24, -2, v24
    v_and_b32 v25, -2, v25
    v_and_b32 v26, -2, v26
    v_and_b32 v27, -2, v27
    v_and_b32 v28, -2, v28
    v_and_b32 v29, -2, v29
    v_and_b32 v30, -2, v30
    v_and_b32 v31, -2, v31
    v_add_f32 v16, v16, v20
    v_add_f32 v24, v24, v28
    v_add_f32 v17, v17, v21
    v_add_f32 v25, v25, v29
    v_add_f32 v18, v18, v22
    v_add_f32 v26, v26, v30
    v_add_f32 v19, v19, v23
    v_add_f32 v27, v27, v31
    v_add_f32 v16, v16, v24
    v_add_f32 v17, v17, v25
    v_add_f32 v18, v18, v26
    v_add_f32 v19, v19, v27
    v_cvt_pk_bf16_f32 v16, v16, v17
    v_cvt_pk_bf16_f32 v18, v18, v19
    ds_write_b16 v6, v16 offset:21504
    ds_write_b16_d16_hi v6, v16 offset:21520
    ds_write_b16 v6, v18 offset:21536
    ds_write_b16_d16_hi v6, v18 offset:21552
    ds_write_b32 v8, v9 offset:21924
    s_mov_b64 exec, -1
    s_mov_b32 s77, 0
L_cp0:
    ds_read_b32 v10, v8 offset:21952
    s_add_u32 s77, s77, 1
    s_waitcnt lgkmcnt(0)
    v_readfirstlane_b32 s69, v10
    s_cmp_ge_u32 s77, 0x40000
    s_cbranch_scc1 L_cp0_done
    s_cmp_ge_u32 s69, 48
    s_cbranch_scc0 L_cp0
L_cp0_done:
    s_mov_b64 exec, 0xffffffff
    buffer_load_dword v14, v12, s[52:55], s73 offen sc0
    s_waitcnt vmcnt(0)
    v_xor_b32 v15, v14, v13
    v_and_b32 v15, 1, v15
    v_cmp_eq_u32 vcc, 1, v15
    v_lshrrev_b32 v14, 1, v14
    v_subrev_u32 v14, s69, v14
    v_med3_i32 v14, v14, -16, 16
    v_cndmask_b32 v14, -2, v14, vcc
    s_nop 1
    v_add_u32_dpp v14, v14, v14 row_ror:8 row_mask:0xf bank_mask:0xf
    s_nop 1
    v_add_u32_dpp v14, v14, v14 row_ror:4 row_mask:0xf bank_mask:0xf
    s_nop 1
    v_add_u32_dpp v14, v14, v14 row_ror:2 row_mask:0xf bank_mask:0xf
    s_nop 1
    v_add_u32_dpp v14, v14, v14 row_ror:1 row_mask:0xf bank_mask:0xf
    s_nop 1
    v_add_u32_dpp v14, v14, v14 row_bcast:15 row_mask:0xa bank_mask:0xf
    s_nop 0
    v_readlane_b32 s4, v14, 31
    s_cmp_lt_i32 s4, -192
    s_cselect_b32 s74, 1, 0
    s_cmp_gt_i32 s4, 0
    s_cselect_b32 s74, 2, s74
    v_mov_b32 v11, s74
    ds_write_b32 v8, v11 offset:21936
    s_mov_b32 s77, 0
L_cp1:
    ds_read_b32 v10, v8 offset:21952
    s_add_u32 s77, s77, 1
    s_waitcnt lgkmcnt(0)
    v_readfirstlane_b32 s69, v10
    s_cmp_ge_u32 s77, 0x40000
    s_cbranch_scc1 L_cp1_done
    s_cmp_ge_u32 s69, 64
    s_cbranch_scc0 L_cp1
L_cp1_done:
    s_mov_b64 exec, 0xffffffff
    buffer_load_dword v14, v12, s[52:55], s73 offen sc0
    s_waitcnt vmcnt(0)
    v_xor_b32 v15, v14, v13
    v_and_b32 v15, 1, v15
    v_cmp_eq_u32 vcc, 1, v15
    v_lshrrev_b32 v14, 1, v14
    v_subrev_u32 v14, s69, v14
    v_med3_i32 v14, v14, -16, 16
    v_cndmask_b32 v14, -2, v14, vcc
    s_nop 1
    v_add_u32_dpp v14, v14, v14 row_ror:8 row_mask:0xf bank_mask:0xf
    s_nop 1
    v_add_u32_dpp v14, v14, v14 row_ror:4 row_mask:0xf bank_mask:0xf
    s_nop 1
    v_add_u32_dpp v14, v14, v14 row_ror:2 row_mask:0xf bank_mask:0xf
    s_nop 1
    v_add_u32_dpp v14, v14, v14 row_ror:1 row_mask:0xf bank_mask:0xf
    s_nop 1
    v_add_u32_dpp v14, v14, v14 row_bcast:15 row_mask:0xa bank_mask:0xf
    s_nop 0
    v_readlane_b32 s4, v14, 31
    s_cmp_lt_i32 s4, -192
    s_cselect_b32 s74, 1, 0
    s_cmp_gt_i32 s4, 0
    s_cselect_b32 s74, 2, s74
    v_mov_b32 v11, s74
    ds_write_b32 v8, v11 offset:21936
    s_mov_b32 s77, 0
L_cp2:
    ds_read_b32 v10, v8 offset:21952
    s_add_u32 s77, s77, 1
    s_waitcnt lgkmcnt(0)
    v_readfirstlane_b32 s69, v10
    s_cmp_ge_u32 s77, 0x40000
    s_cbranch_scc1 L_cp2_done
    s_cmp_ge_u32 s69, 80
    s_cbranch_scc0 L_cp2
L_cp2_done:
    s_mov_b64 exec, 0xffffffff
    buffer_load_dword v14, v12, s[52:55], s73 offen sc0
    s_waitcnt vmcnt(0)
    v_xor_b32 v15, v14, v13
    v_and_b32 v15, 1, v15
    v_cmp_eq_u32 vcc, 1, v15
    v_lshrrev_b32 v14, 1, v14
    v_subrev_u32 v14, s69, v14
    v_med3_i32 v14, v14, -16, 16
    v_cndmask_b32 v14, -2, v14, vcc
    s_nop 1
    v_add_u32_dpp v14, v14, v14 row_ror:8 row_mask:0xf bank_mask:0xf
    s_nop 1
    v_add_u32_dpp v14, v14, v14 row_ror:4 row_mask:0xf bank_mask:0xf
    s_nop 1
    v_add_u32_dpp v14, v14, v14 row_ror:2 row_mask:0xf bank_mask:0xf
    s_nop 1
    v_add_u32_dpp v14, v14, v14 row_ror:1 row_mask:0xf bank_mask:0xf
    s_nop 1
    v_add_u32_dpp v14, v14, v14 row_bcast:15 row_mask:0xa bank_mask:0xf
    s_nop 0
    v_readlane_b32 s4, v14, 31
    s_cmp_lt_i32 s4, -192
    s_cselect_b32 s74, 1, 0
    s_cmp_gt_i32 s4, 0
    s_cselect_b32 s74, 2, s74
    v_mov_b32 v11, s74
    ds_write_b32 v8, v11 offset:21936
    s_mov_b32 s77, 0
L_cp3:
    ds_read_b32 v10, v8 offset:21952
    s_add_u32 s77, s77, 1
    s_waitcnt lgkmcnt(0)
    v_readfirstlane_b32 s69, v10
    s_cmp_ge_u32 s77, 0x40000
    s_cbranch_scc1 L_cp3_done
    s_cmp_ge_u32 s69, 96
    s_cbranch_scc0 L_cp3
L_cp3_done:
    s_mov_b64 exec, 0xffffffff
    buffer_load_dword v14, v12, s[52:55], s73 offen sc0
    s_waitcnt vmcnt(0)
    v_xor_b32 v15, v14, v13
    v_and_b32 v15, 1, v15
    v_cmp_eq_u32 vcc, 1, v15
    v_lshrrev_b32 v14, 1, v14
    v_subrev_u32 v14, s69, v14
    v_med3_i32 v14, v14, -16, 16
    v_cndmask_b32 v14, -2, v14, vcc
    s_nop 1
    v_add_u32_dpp v14, v14, v14 row_ror:8 row_mask:0xf bank_mask:0xf
    s_nop 1
    v_add_u32_dpp v14, v14, v14 row_ror:4 row_mask:0xf bank_mask:0xf
    s_nop 1
    v_add_u32_dpp v14, v14, v14 row_ror:2 row_mask:0xf bank_mask:0xf
    s_nop 1
    v_add_u32_dpp v14, v14, v14 row_ror:1 row_mask:0xf bank_mask:0xf
    s_nop 1
    v_add_u32_dpp v14, v14, v14 row_bcast:15 row_mask:0xa bank_mask:0xf
    s_nop 0
    v_readlane_b32 s4, v14, 31
    s_cmp_lt_i32 s4, -192
    s_cselect_b32 s74, 1, 0
    s_cmp_gt_i32 s4, 0
    s_cselect_b32 s74, 2, s74
    v_mov_b32 v11, s74
    ds_write_b32 v8, v11 offset:21936
    s_mov_b32 s77, 0
L_cp4:
    ds_read_b32 v10, v8 offset:21952
    s_add_u32 s77, s77, 1
    s_waitcnt lgkmcnt(0)
    v_readfirstlane_b32 s69, v10
    s_cmp_ge_u32 s77, 0x40000
    s_cbranch_scc1 L_cp4_done
    s_cmp_ge_u32 s69, 112
    s_cbranch_scc0 L_cp4
L_cp4_done:
    s_mov_b64 exec, 0xffffffff
    buffer_load_dword v14, v12, s[52:55], s73 offen sc0
    s_waitcnt vmcnt(0)
    v_xor_b32 v15, v14, v13
    v_and_b32 v15, 1, v15
    v_cmp_eq_u32 vcc, 1, v15
    v_lshrrev_b32 v14, 1, v14
    v_subrev_u32 v14, s69, v14
    v_med3_i32 v14, v14, -16, 16
    v_cndmask_b32 v14, -2, v14, vcc
    s_nop 1
    v_add_u32_dpp v14, v14, v14 row_ror:8 row_mask:0xf bank_mask:0xf
    s_nop 1
    v_add_u32_dpp v14, v14, v14 row_ror:4 row_mask:0xf bank_mask:0xf
    s_nop 1
    v_add_u32_dpp v14, v14, v14 row_ror:2 row_mask:0xf bank_mask:0xf
    s_nop 1
    v_add_u32_dpp v14, v14, v14 row_ror:1 row_mask:0xf bank_mask:0xf
    s_nop 1
    v_add_u32_dpp v14, v14, v14 row_bcast:15 row_mask:0xa bank_mask:0xf
    s_nop 0
    v_readlane_b32 s4, v14, 31
    s_cmp_lt_i32 s4, -192
    s_cselect_b32 s74, 1, 0
    s_cmp_gt_i32 s4, 0
    s_cselect_b32 s74, 2, s74
    v_mov_b32 v11, s74
    ds_write_b32 v8, v11 offset:21936
    s_mov_b32 s77, 0
L_cp5:
    ds_read_b32 v10, v8 offset:21952
    s_add_u32 s77, s77, 1
    s_waitcnt lgkmcnt(0)
    v_readfirstlane_b32 s69, v10
    s_cmp_ge_u32 s77, 0x40000
    s_cbranch_scc1 L_cp5_done
    s_cmp_ge_u32 s69, 128
    s_cbranch_scc0 L_cp5
L_cp5_done:
    s_mov_b64 exec, 0xffffffff
    buffer_load_dword v14, v12, s[52:55], s73 offen sc0
    s_waitcnt vmcnt(0)
    v_xor_b32 v15, v14, v13
    v_and_b32 v15, 1, v15
    v_cmp_eq_u32 vcc, 1, v15
    v_lshrrev_b32 v14, 1, v14
    v_subrev_u32 v14, s69, v14
    v_med3_i32 v14, v14, -16, 16
    v_cndmask_b32 v14, -2, v14, vcc
    s_nop 1
    v_add_u32_dpp v14, v14, v14 row_ror:8 row_mask:0xf bank_mask:0xf
    s_nop 1
    v_add_u32_dpp v14, v14, v14 row_ror:4 row_mask:0xf bank_mask:0xf
    s_nop 1
    v_add_u32_dpp v14, v14, v14 row_ror:2 row_mask:0xf bank_mask:0xf
    s_nop 1
    v_add_u32_dpp v14, v14, v14 row_ror:1 row_mask:0xf bank_mask:0xf
    s_nop 1
    v_add_u32_dpp v14, v14, v14 row_bcast:15 row_mask:0xa bank_mask:0xf
    s_nop 0
    v_readlane_b32 s4, v14, 31
    s_cmp_lt_i32 s4, -192
    s_cselect_b32 s74, 1, 0
    s_cmp_gt_i32 s4, 0
    s_cselect_b32 s74, 2, s74
    v_mov_b32 v11, s74
    ds_write_b32 v8, v11 offset:21936
    s_mov_b32 s77, 0
L_cp6:
    ds_read_b32 v10, v8 offset:21952
    s_add_u32 s77, s77, 1
    s_waitcnt lgkmcnt(0)
    v_readfirstlane_b32 s69, v10
    s_cmp_ge_u32 s77, 0x40000
    s_cbranch_scc1 L_cp6_done
    s_cmp_ge_u32 s69, 144
    s_cbranch_scc0 L_cp6
L_cp6_done:
    s_mov_b64 exec, 0xffffffff
    buffer_load_dword v14, v12, s[52:55], s73 offen sc0
    s_waitcnt vmcnt(0)
    v_xor_b32 v15, v14, v13
    v_and_b32 v15, 1, v15
    v_cmp_eq_u32 vcc, 1, v15
    v_lshrrev_b32 v14, 1, v14
    v_subrev_u32 v14, s69, v14
    v_med3_i32 v14, v14, -16, 16
    v_cndmask_b32 v14, -2, v14, vcc
    s_nop 1
    v_add_u32_dpp v14, v14, v14 row_ror:8 row_mask:0xf bank_mask:0xf
    s_nop 1
    v_add_u32_dpp v14, v14, v14 row_ror:4 row_mask:0xf bank_mask:0xf
    s_nop 1
    v_add_u32_dpp v14, v14, v14 row_ror:2 row_mask:0xf bank_mask:0xf
    s_nop 1
    v_add_u32_dpp v14, v14, v14 row_ror:1 row_mask:0xf bank_mask:0xf
    s_nop 1
    v_add_u32_dpp v14, v14, v14 row_bcast:15 row_mask:0xa bank_mask:0xf
    s_nop 0
    v_readlane_b32 s4, v14, 31
    s_cmp_lt_i32 s4, -192
    s_cselect_b32 s74, 1, 0
    s_cmp_gt_i32 s4, 0
    s_cselect_b32 s74, 2, s74
    v_mov_b32 v11, s74
    ds_write_b32 v8, v11 offset:21936
    s_mov_b32 s77, 0
L_cp7:
    ds_read_b32 v10, v8 offset:21952
    s_add_u32 s77, s77, 1
    s_waitcnt lgkmcnt(0)
    v_readfirstlane_b32 s69, v10
    s_cmp_ge_u32 s77, 0x40000
    s_cbranch_scc1 L_cp7_done
    s_cmp_ge_u32 s69, 160
    s_cbranch_scc0 L_cp7
L_cp7_done:
    s_mov_b64 exec, 0xffffffff
    buffer_load_dword v14, v12, s[52:55], s73 offen sc0
    s_waitcnt vmcnt(0)
    v_xor_b32 v15, v14, v13
    v_and_b32 v15, 1, v15
    v_cmp_eq_u32 vcc, 1, v15
    v_lshrrev_b32 v14, 1, v14
    v_subrev_u32 v14, s69, v14
    v_med3_i32 v14, v14, -16, 16
    v_cndmask_b32 v14, -2, v14, vcc
    s_nop 1
    v_add_u32_dpp v14, v14, v14 row_ror:8 row_mask:0xf bank_mask:0xf
    s_nop 1
    v_add_u32_dpp v14, v14, v14 row_ror:4 row_mask:0xf bank_mask:0xf
    s_nop 1
    v_add_u32_dpp v14, v14, v14 row_ror:2 row_mask:0xf bank_mask:0xf
    s_nop 1
    v_add_u32_dpp v14, v14, v14 row_ror:1 row_mask:0xf bank_mask:0xf
    s_nop 1
    v_add_u32_dpp v14, v14, v14 row_bcast:15 row_mask:0xa bank_mask:0xf
    s_nop 0
    v_readlane_b32 s4, v14, 31
    s_cmp_lt_i32 s4, -192
    s_cselect_b32 s74, 1, 0
    s_cmp_gt_i32 s4, 0
    s_cselect_b32 s74, 2, s74
    v_mov_b32 v11, s74
    ds_write_b32 v8, v11 offset:21936
    s_mov_b32 s77, 0
L_cp8:
    ds_read_b32 v10, v8 offset:21952
    s_add_u32 s77, s77, 1
    s_waitcnt lgkmcnt(0)
    v_readfirstlane_b32 s69, v10
    s_cmp_ge_u32 s77, 0x40000
    s_cbranch_scc1 L_cp8_done
    s_cmp_ge_u32 s69, 176
    s_cbranch_scc0 L_cp8
L_cp8_done:
    s_mov_b64 exec, 0xffffffff
    buffer_load_dword v14, v12, s[52:55], s73 offen sc0
    s_waitcnt vmcnt(0)
    v_xor_b32 v15, v14, v13
    v_and_b32 v15, 1, v15
    v_cmp_eq_u32 vcc, 1, v15
    v_lshrrev_b32 v14, 1, v14
    v_subrev_u32 v14, s69, v14
    v_med3_i32 v14, v14, -16, 16
    v_cndmask_b32 v14, -2, v14, vcc
    s_nop 1
    v_add_u32_dpp v14, v14, v14 row_ror:8 row_mask:0xf bank_mask:0xf
    s_nop 1
    v_add_u32_dpp v14, v14, v14 row_ror:4 row_mask:0xf bank_mask:0xf
    s_nop 1
    v_add_u32_dpp v14, v14, v14 row_ror:2 row_mask:0xf bank_mask:0xf
    s_nop 1
    v_add_u32_dpp v14, v14, v14 row_ror:1 row_mask:0xf bank_mask:0xf
    s_nop 1
    v_add_u32_dpp v14, v14, v14 row_bcast:15 row_mask:0xa bank_mask:0xf
    s_nop 0
    v_readlane_b32 s4, v14, 31
    s_cmp_lt_i32 s4, -192
    s_cselect_b32 s74, 1, 0
    s_cmp_gt_i32 s4, 0
    s_cselect_b32 s74, 2, s74
    v_mov_b32 v11, s74
    ds_write_b32 v8, v11 offset:21936
    s_mov_b32 s77, 0
L_cp9:
    ds_read_b32 v10, v8 offset:21952
    s_add_u32 s77, s77, 1
    s_waitcnt lgkmcnt(0)
    v_readfirstlane_b32 s69, v10
    s_cmp_ge_u32 s77, 0x40000
    s_cbranch_scc1 L_cp9_done
    s_cmp_ge_u32 s69, 192
    s_cbranch_scc0 L_cp9
L_cp9_done:
    s_mov_b64 exec, 0xffffffff
    buffer_load_dword v14, v12, s[52:55], s73 offen sc0
    s_waitcnt vmcnt(0)
    v_xor_b32 v15, v14, v13
    v_and_b32 v15, 1, v15
    v_cmp_eq_u32 vcc, 1, v15
    v_lshrrev_b32 v14, 1, v14
    v_subrev_u32 v14, s69, v14
    v_med3_i32 v14, v14, -16, 16
    v_cndmask_b32 v14, -2, v14, vcc
    s_nop 1
    v_add_u32_dpp v14, v14, v14 row_ror:8 row_mask:0xf bank_mask:0xf
    s_nop 1
    v_add_u32_dpp v14, v14, v14 row_ror:4 row_mask:0xf bank_mask:0xf
    s_nop 1
    v_add_u32_dpp v14, v14, v14 row_ror:2 row_mask:0xf bank_mask:0xf
    s_nop 1
    v_add_u32_dpp v14, v14, v14 row_ror:1 row_mask:0xf bank_mask:0xf
    s_nop 1
    v_add_u32_dpp v14, v14, v14 row_bcast:15 row_mask:0xa bank_mask:0xf
    s_nop 0
    v_readlane_b32 s4, v14, 31
    s_cmp_lt_i32 s4, -192
    s_cselect_b32 s74, 1, 0
    s_cmp_gt_i32 s4, 0
    s_cselect_b32 s74, 2, s74
    v_mov_b32 v11, s74
    ds_write_b32 v8, v11 offset:21936
    s_mov_b64 exec, -1
    v_and_b32 v6, 3, v0
    v_lshlrev_b32 v6, 3, v6
    s_waitcnt lgkmcnt(0)
    s_barrier
    ds_read_b64 v[8:9], v6 offset:21888
    s_waitcnt lgkmcnt(0)
    v_max_f32_dpp v10, v8, v8 quad_perm:[1,0,3,2] row_mask:0xf bank_mask:0xf
    s_nop 1
    v_max_f32_dpp v10, v10, v10 quad_perm:[2,3,0,1] row_mask:0xf bank_mask:0xf
    v_sub_f32 v8, v8, v10
    v_exp_f32 v8, v8
    s_nop 0
    v_mul_f32 v11, v8, v9
    s_nop 1
    v_add_f32_dpp v11, v11, v11 quad_perm:[1,0,3,2] row_mask:0xf bank_mask:0xf
    s_nop 1
    v_add_f32_dpp v11, v11, v11 quad_perm:[2,3,0,1] row_mask:0xf bank_mask:0xf
    s_mov_b64 exec, 1
    v_min_u32 v10, -2, v10
    v_min_u32 v11, -2, v11
    buffer_store_dwordx2 v[10:11], v6, s[52:55], s70 offen sc1
    s_mov_b64 exec, -1
    s_branch L_h5
L_hG:
    v_and_b32 v7, 63, v0
    v_lshlrev_b32 v7, 2, v7
    v_and_b32 v6, 63, v0
    v_lshlrev_b32 v6, 4, v6
    v_mov_b32 v8, 0
    v_mov_b32 v9, 1
    s_and_b32 s71, s68, -4
    s_waitcnt lgkmcnt(0)
    s_mov_b32 s52, s28
    s_and_b32 s53, s29, 0xffff
    s_mov_b32 s54, 917504
    s_mov_b32 s55, 0x20000
    s_mov_b32 s56, s24
    s_and_b32 s57, s25, 0xffff
    s_mov_b32 s58, 2560
    s_mov_b32 s59, 0x20000
    s_mov_b32 s60, s26
    s_and_b32 s61, s27, 0xffff
    s_mov_b32 s62, 256
    s_mov_b32 s63, 0x20000
    s_bfe_u32 s97, s2, 0x10002
    s_xor_b32 s97, s97, 1
    s_lshr_b32 s98, s2, 3
    s_lshl_b32 s98, s98, 2
    s_and_b32 s99, s2, 3
    s_add_u32 s98, s98, s99
    s_lshl_b32 s98, s98, 6
    s_mul_i32 s96, s97, 327680
    s_add_u32 s96, s96, s98
    s_mul_i32 s99, s97, 1280
    s_add_u32 s98, s98, s99
    s_lshl_b32 s97, s97, 10
    s_add_u32 s97, s97, 655360
    s_mov_b32 s99, 0
    s_and_b32 s80, s2, 7
    s_lshl_b32 s80, s80, 6
    s_lshr_b32 s81, s2, 3
    s_add_u32 s80, s80, s81
    s_lshl_b32 s80, s80, 2
    s_add_u32 s80, s80, 884736
    s_mov_b64 exec, 1
    buffer_load_dword v14, v8, s[52:55], s80 offen sc0
    s_mov_b64 exec, -1
    s_barrier
    v_mov_b32 v16, -1
    v_mov_b32 v17, -1
    v_mov_b32 v18, -1
    v_mov_b32 v19, -1
    s_mul_i32 s69, s68, 2560
    s_lshl_b32 s70, s68, 3
    s_add_u32 s70, s70, 655360
    buffer_store_dwordx4 v[16:19], v6, s[52:55], s69 offen sc1
    buffer_store_dwordx4 v[16:19], v6, s[52:55], s69 offen offset:1024 sc1
    s_mov_b64 exec, 0xffffffff
    buffer_store_dwordx4 v[16:19], v6, s[52:55], s69 offen offset:2048 sc1
    s_mov_b64 exec, 1
    buffer_store_dwordx2 v[16:17], v6, s[52:55], s70 offen sc1
    s_mov_b64 exec, 1
    s_mov_b32 s77, 0
L_ack:
    ds_read_b32 v10, v8 offset:21928
    s_add_u32 s77, s77, 1
    s_waitcnt lgkmcnt(0)
    v_readfirstlane_b32 s69, v10
    s_cmp_ge_u32 s77, 0x40000
    s_cbranch_scc1 L_ack_done
    s_cmp_lg_u32 s69, 0
    s_cbranch_scc0 L_ack
L_ack_done:
    s_waitcnt vmcnt(0)
    buffer_atomic_add v9, v8, s[60:63], s72 offen sc1
    v_not_b32 v14, v14
    v_and_b32 v14, 1, v14
    s_mov_b32 s74, 4
    s_mov_b32 s77, 0
L_pub:
    ds_read_b32 v10, v8 offset:21952
    s_add_u32 s77, s77, 1
    s_waitcnt lgkmcnt(0)
    v_readfirstlane_b32 s69, v10
    s_cmp_ge_u32 s77, 0x40000
    s_cbranch_scc1 L_pub_done
    s_cmp_lt_u32 s69, s74
    s_cbranch_scc1 L_pub
    v_lshl_or_b32 v11, v10, 1, v14
    buffer_store_dword v11, v8, s[52:55], s80 offen
    s_add_u32 s74, s69, 4
    s_cmp_le_u32 s74, 200
    s_cbranch_scc1 L_pub
L_pub_done:
    s_mov_b64 exec, -1
    s_cmp_ge_u32 s2, 40
    s_cbranch_scc1 L_g3
    s_mov_b32 s77, 0
    buffer_load_dword v10, v7, s[60:63], 0 offen sc1
    v_lshrrev_b32 v56, 3, v0
    v_mul_u32_u24 v56, 2560, v56
    v_bfe_u32 v60, v0, 2, 1
    v_mul_u32_u24 v60, 1280, v60
    v_add_u32 v56, v56, v60
    v_and_b32 v60, 3, v0
    v_lshl_add_u32 v56, v60, 4, v56
    s_barrier
    s_branch L_chk1
L_chk:
    buffer_load_dword v10, v7, s[60:63], 0 offen sc1
L_chk1:
    s_add_u32 s77, s77, 1
    s_waitcnt vmcnt(0)
    v_cmp_gt_u32 vcc, 4, v10
    s_cmp_ge_u32 s77, 0x8000
    s_cbranch_scc1 L_chk2
    s_cbranch_vccnz L_chk
L_chk2:
    v_lshrrev_b32 v19, 1, v6
    s_mov_b32 s77, 0
    s_barrier
    buffer_load_dwordx4 v[20:23], v6, s[52:55], s97 offen sc1
    s_barrier
    buffer_load_dwordx4 v[64:67], v56, s[52:55], s96 offen sc1
    s_waitcnt vmcnt(1)
L_ml:
    v_max3_u32 v24, v20, v21, v22
    v_max_u32 v24, v24, v23
    v_cmp_eq_u32 vcc, -1, v24
    s_add_u32 s77, s77, 1
    s_cbranch_vccz L_mlok
    s_cmp_ge_u32 s77, 0x8000
    s_cbranch_scc1 L_mlok
    s_mov_b64 exec, vcc
    buffer_load_dwordx4 v[20:23], v6, s[52:55], s97 offen sc1
    s_mov_b64 exec, -1
    s_waitcnt vmcnt(0)
    s_branch L_ml
L_mlok:
    v_max_f32 v24, v20, v22
    s_nop 1
    v_max_f32_dpp v24, v24, v24 quad_perm:[1,0,3,2] row_mask:0xf bank_mask:0xf
    v_sub_f32 v20, v20, v24
    v_sub_f32 v22, v22, v24
    v_exp_f32 v20, v20
    v_exp_f32 v22, v22
    s_nop 0
    v_mul_f32 v21, v21, v20
    v_fmac_f32 v21, v23, v22
    s_nop 1
    v_add_f32_dpp v21, v21, v21 quad_perm:[1,0,3,2] row_mask:0xf bank_mask:0xf
    v_rcp_f32 v21, v21
    s_nop 0
    v_mul_f32 v24, v20, v21
    v_mul_f32 v25, v22, v21
    ds_write_b64 v19, v[24:25] offset:0
    s_waitcnt lgkmcnt(0)
    s_branch L_b5
L_g3:
    s_barrier
L_h5:
    v_lshrrev_b32 v56, 3, v0
    v_mul_u32_u24 v56, 2560, v56
    v_bfe_u32 v60, v0, 2, 1
    v_mul_u32_u24 v60, 1280, v60
    v_add_u32 v56, v56, v60
    v_and_b32 v60, 3, v0
    v_lshl_add_u32 v56, v60, 4, v56
    s_cmp_ge_u32 s2, 40
    s_barrier
    s_barrier
    s_cbranch_scc1 L_fin
    buffer_load_dwordx4 v[64:67], v56, s[52:55], s96 offen sc1
L_tail:
L_b5:
    v_lshrrev_b32 v60, 3, v0
    v_lshlrev_b32 v60, 2, v60
    s_barrier
    buffer_load_dwordx4 v[68:71], v56, s[52:55], s96 offen sc1
    ds_read_b32 v58, v60 offset:0
    v_and_b32 v57, 3, v0
    v_lshlrev_b32 v57, 5, v57
    v_bfe_u32 v60, v0, 5, 1
    v_lshl_add_u32 v57, v60, 4, v57
    v_bfe_u32 v60, v0, 4, 1
    v_lshl_add_u32 v57, v60, 3, v57
    v_bfe_u32 v60, v0, 3, 1
    v_lshl_add_u32 v57, v60, 2, v57
    v_lshrrev_b32 v60, 6, v0
    v_lshl_add_u32 v57, v60, 7, v57
    v_and_b32 v62, 31, v0
    v_lshrrev_b32 v60, 5, v0
    v_lshlrev_b32 v61, 2, v62
    v_lshl_add_u32 v61, v60, 10, v61
    v_lshlrev_b32 v62, 1, v62
    s_mov_b32 s78, 0x0f0f0f0f
    s_mov_b32 s79, 0x0f0f0f0f
    s_mov_b32 s84, 0xffff0000
    s_mov_b64 s[100:101], -1
    s_mov_b32 s77, 0
    s_waitcnt lgkmcnt(0)
    s_cmp_eq_u32 s99, 0
    s_cbranch_scc1 L_py0
    s_waitcnt vmcnt(2)
    s_branch L_pc0
L_py0:
    s_waitcnt vmcnt(1)
L_pc0:
    v_max3_u32 v60, v64, v65, v66
    v_max_u32 v60, v60, v67
    v_cmp_ne_u32 vcc, -1, v60
    s_add_u32 s77, s77, 1
    s_cbranch_vccz L_pn0
    s_mov_b64 exec, vcc
    v_lshlrev_b32 v80, 16, v64
    v_and_b32 v81, s84, v64
    v_lshlrev_b32 v82, 16, v65
    v_and_b32 v83, s84, v65
    v_lshlrev_b32 v84, 16, v66
    v_and_b32 v85, s84, v66
    v_lshlrev_b32 v86, 16, v67
    v_and_b32 v87, s84, v67
    s_andn2_b64 s[100:101], s[100:101], vcc
    v_pk_mul_f32 v[80:81], v[80:81], v[58:59] op_sel_hi:[1,0]
    v_pk_mul_f32 v[82:83], v[82:83], v[58:59] op_sel_hi:[1,0]
    v_pk_mul_f32 v[84:85], v[84:85], v[58:59] op_sel_hi:[1,0]
    v_pk_mul_f32 v[86:87], v[86:87], v[58:59] op_sel_hi:[1,0]
    s_cbranch_scc0 L_pdone
    s_mov_b64 exec, s[100:101]
L_pn0:
    buffer_load_dwordx4 v[64:67], v56, s[52:55], s96 offen sc1
L_py1:
    s_waitcnt vmcnt(1)
L_pc1:
    v_max3_u32 v60, v68, v69, v70
    v_max_u32 v60, v60, v71
    v_cmp_ne_u32 vcc, -1, v60
    s_add_u32 s77, s77, 1
    s_cbranch_vccz L_pn1
    s_mov_b64 exec, vcc
    v_lshlrev_b32 v80, 16, v68
    v_and_b32 v81, s84, v68
    v_lshlrev_b32 v82, 16, v69
    v_and_b32 v83, s84, v69
    v_lshlrev_b32 v84, 16, v70
    v_and_b32 v85, s84, v70
    v_lshlrev_b32 v86, 16, v71
    v_and_b32 v87, s84, v71
    s_andn2_b64 s[100:101], s[100:101], vcc
    v_pk_mul_f32 v[80:81], v[80:81], v[58:59] op_sel_hi:[1,0]
    v_pk_mul_f32 v[82:83], v[82:83], v[58:59] op_sel_hi:[1,0]
    v_pk_mul_f32 v[84:85], v[84:85], v[58:59] op_sel_hi:[1,0]
    v_pk_mul_f32 v[86:87], v[86:87], v[58:59] op_sel_hi:[1,0]
    s_cbranch_scc0 L_pdone
    s_mov_b64 exec, s[100:101]
L_pn1:
    buffer_load_dwordx4 v[68:71], v56, s[52:55], s96 offen sc1
    s_cmp_lt_u32 s77, 0x8000
    s_cbranch_scc1 L_py0
L_pdone:
    s_mov_b64 exec, -1
    s_nop 0
    v_permlane32_swap_b32 v80, v84
    v_permlane32_swap_b32 v81, v85
    v_permlane32_swap_b32 v82, v86
    v_permlane32_swap_b32 v83, v87
    v_pk_add_f32 v[80:81], v[80:81], v[84:85]
    v_pk_add_f32 v[82:83], v[82:83], v[86:87]
    s_nop 1
    v_permlane16_swap_b32 v80, v82
    v_permlane16_swap_b32 v81, v83
    v_pk_add_f32 v[80:81], v[80:81], v[82:83]
    s_nop 1
    v_add_f32_dpp v80, v80, v80 row_ror:8 row_mask:0xf bank_mask:0x3
    v_add_f32_dpp v80, v81, v81 row_ror:8 row_mask:0xf bank_mask:0xc
    s_nop 1
    v_add_f32_dpp v80, v80, v80 row_shl:4 row_mask:0xf bank_mask:0x5
    s_mov_b64 exec, s[78:79]
    ds_write_b32 v57, v80 offset:21952
    s_cmp_lg_u32 s64, 0
    s_waitcnt lgkmcnt(0)
    s_barrier
    s_cbranch_scc1 L_fin
    s_mov_b64 exec, -1
    ds_read_b32 v40, v61 offset:21952
    ds_read_b32 v41, v61 offset:22080
    ds_read_b32 v42, v61 offset:22208
    ds_read_b32 v43, v61 offset:22336
    ds_read_b32 v44, v61 offset:22464
    ds_read_b32 v45, v61 offset:22592
    ds_read_b32 v46, v61 offset:22720
    ds_read_b32 v47, v61 offset:22848
    s_waitcnt lgkmcnt(6)
    v_add_f32 v40, v40, v41
    s_waitcnt lgkmcnt(4)
    v_add_f32 v42, v42, v43
    s_waitcnt lgkmcnt(2)
    v_add_f32 v44, v44, v45
    s_waitcnt lgkmcnt(0)
    v_add_f32 v46, v46, v47
    v_add_f32 v40, v40, v42
    v_add_f32 v44, v44, v46
    v_add_f32 v40, v40, v44
    v_mov_b32 v41, v40
    s_nop 1
    v_permlane32_swap_b32 v40, v41
    v_add_f32 v40, v40, v41
    v_cvt_pk_bf16_f32 v40, v40, v40
    s_mov_b64 exec, 0xffffffff
    buffer_store_short v40, v62, s[56:59], s98 offen
L_fin:
L_end:
    s_endpgm
.section .rodata,"a"
.p2align 6
.amdhsa_kernel concat_heads__mha_block_cached__gqa_block_cached__decode_kernel
  .amdhsa_next_free_vgpr 128
  .amdhsa_next_free_sgpr 102
  .amdhsa_accum_offset 128
  .amdhsa_group_segment_fixed_size 0
  .amdhsa_kernarg_size 104
  .amdhsa_user_sgpr_count 2
  .amdhsa_user_sgpr_kernarg_segment_ptr 1
  .amdhsa_system_sgpr_workgroup_id_x 1
.end_amdhsa_kernel
```
